```python
import torch

def _softmax(x, axis=-1):
    return torch.softmax(x, dim=axis)
def _gelu(x):
    return torch.nn.functional.gelu(x, approximate="tanh")
def _silu(x):
    return torch.nn.functional.silu(x)
def _sigmoid(x):
    return torch.sigmoid(x)
def _layernorm(x, axis=-1, eps=1e-5):
    m = x.mean(dim=axis, keepdim=True)
    v = x.var(dim=axis, keepdim=True, unbiased=False)
    return (x - m) / torch.sqrt(v + eps)
def _scatter_add(tgt, idx, src, axis=0):
    return tgt.clone().index_add_(axis, idx, src)
def _segment_sum(src, seg, n):
    out = torch.zeros((n,) + src.shape[1:], dtype=src.dtype)
    return out.index_add_(0, seg, src)
def _pad(x, pw):
    flat = tuple(v for pair in reversed(pw) for v in pair)
    return torch.nn.functional.pad(x, flat)

kernel_name = 'concat_heads__sliding_block_cached__compressed_kv_cla__decode'

def setup_inputs():

    _w = (lambda a: (lambda t: t.to(torch.bfloat16) if t.is_floating_point() else t)(torch.as_tensor(a)))
    def _A_setup():
        B, Sq, D = 2, 1, 512
        Hq, Hkv, Sk, Dh = 32, 32, 8192, 128
        assert Hq % Hkv == 0, (Hq, Hkv)
        return {
            "x": _w((lambda *s: torch.randn(*s, dtype=torch.bfloat16) * 1.6)(B, Sq, D)),
            "k_cache": _w((lambda *s: torch.randn(*s, dtype=torch.bfloat16) * 1.6)(B, Hkv, Sk, Dh)),
            "v_cache": _w((lambda *s: torch.randn(*s, dtype=torch.bfloat16) * 0.05)(B, Hkv, Sk, Dh)),
            "wq": _w((lambda *s: torch.randn(*s, dtype=torch.bfloat16) * 1.6)(D, Hq * Dh) * (D ** -0.5)),
            "wo": _w((lambda *s: torch.randn(*s, dtype=torch.bfloat16) * 0.05)(Hq * Dh, D) * ((Hq * Dh) ** -0.5)),
        }
    _A_in = _A_setup()

    def _B_setup():
        B, H, Sq, Sk, D, M = 2, 32, 1, 8192, 128, 512
        Dc = 4 * D
        return {
            "x": _w((lambda *s: torch.randn(*s, dtype=torch.bfloat16) * 3.2)(B, Sq, M)),
            "c_kv": _w((lambda *s: torch.randn(*s, dtype=torch.bfloat16) * 0.1)(B, Sk, Dc)),
            "w_q": _w((lambda *s: torch.randn(*s, dtype=torch.bfloat16) * 6.4)(M, H, D) * (M ** -0.5)),
            "w_uk": _w((lambda *s: torch.randn(*s, dtype=torch.bfloat16) * 6.4)(Dc, H, D) * (Dc ** -0.5)),
            "w_uv": _w((lambda *s: torch.randn(*s, dtype=torch.bfloat16) * 0.1)(Dc, H, D) * (Dc ** -0.5)),
            "w_o": _w((lambda *s: torch.randn(*s, dtype=torch.bfloat16) * 0.1)(H, D, M) * ((H * D) ** -0.5)),
        }
    _B_in = _B_setup()

    return {
        "A_x": _A_in["x"],
        "A_k_cache": _A_in["k_cache"],
        "A_v_cache": _A_in["v_cache"],
        "A_wq": _A_in["wq"],
        "A_wo": _A_in["wo"],
        "B_x": _B_in["x"],
        "B_c_kv": _B_in["c_kv"],
        "B_w_q": _B_in["w_q"],
        "B_w_uk": _B_in["w_uk"],
        "B_w_uv": _B_in["w_uv"],
        "B_w_o": _B_in["w_o"],
    }

def reference(A_x, A_k_cache, A_v_cache, A_wq, A_wo, B_x, B_c_kv, B_w_q, B_w_uk, B_w_uv, B_w_o):
    def _A_ref(x, k_cache, v_cache, wq, wo):
        B, Sq, D = x.shape
        Hq, Dh = 32, 128
        Hkv, Sk = k_cache.shape[1], k_cache.shape[2]
        W = min(4096, max(256, Sk // 4))
        rep = Hq // Hkv
        q = (lambda x, *d: x.permute(*d))((x @ wq).reshape(B, Sq, Hq, Dh), 0, 2, 1, 3)
        k = (lambda x, n, axis: torch.repeat_interleave(x, n, dim=axis))(k_cache[:, :, Sk - W:, :], rep, axis=1)
        v = (lambda x, n, axis: torch.repeat_interleave(x, n, dim=axis))(v_cache[:, :, Sk - W:, :], rep, axis=1)
        scores = torch.einsum("bhqd,bhkd->bhqk", q, k) * (Dh ** -0.5)
        p = _softmax(scores, axis=-1)
        o = torch.einsum("bhqk,bhkd->bhqd", p, v)
        return (lambda x, *d: x.permute(*d))(o, 0, 2, 1, 3).reshape(B, Sq, Hq * Dh) @ wo

    def _B_ref(x, c_kv, w_q, w_uk, w_uv, w_o):
        B, Sq, M = x.shape[0], x.shape[1], x.shape[2]
        Sk = c_kv.shape[1]
        H, D = w_q.shape[1], w_q.shape[2]
        q = torch.einsum("bqm,mhd->bhqd", x, w_q)
        k = torch.einsum("bkc,chd->bhkd", c_kv, w_uk)
        v = torch.einsum("bkc,chd->bhkd", c_kv, w_uv)
        scores = torch.einsum("bhqd,bhkd->bhqk", q, k) * (D ** -0.5)
        off = Sk - Sq
        qi = torch.arange(Sq)[:, None]
        kj = torch.arange(Sk)[None, :]
        cmask = kj <= (qi + off)
        scores = torch.where(cmask[None, None], scores, -1e9)
        p = _softmax(scores, axis=-1)
        ctx = torch.einsum("bhqk,bhkd->bhqd", p, v)
        return torch.einsum("bhqd,hdm->bqm", ctx, w_o)

    a = _A_ref(A_x, A_k_cache, A_v_cache, A_wq, A_wo)
    b = _B_ref(B_x, B_c_kv, B_w_q, B_w_uk, B_w_uv, B_w_o)
    return torch.concatenate([a, b], axis=-1)
```

```asm
; @launch grid=(256,1,1) block=(256,1,1) lds=163840
.amdgcn_target "amdgcn-amd-amdhsa--gfx950"
.text
.globl concat_heads__sliding_block_cached__compressed_kv_cla__decode_kernel
.p2align 8
.type concat_heads__sliding_block_cached__compressed_kv_cla__decode_kernel,@function
concat_heads__sliding_block_cached__compressed_kv_cla__decode_kernel:
    s_load_dwordx16 s[8:23], s[0:1], 0
    s_load_dwordx8 s[24:31], s[0:1], 64
    s_load_dwordx4 s[32:35], s[0:1], 96
    s_cmp_ge_u32 s2, 256
    s_cbranch_scc1 L_exit
    s_getpc_b64 s[40:41]
L_pc:
    s_lshr_b32 s63, s2, 3
    v_lshl_add_u32 v4, s63, 4, v0
    v_lshlrev_b32 v4, 7, v4
    v_min_u32 v4, L_code_end - L_pc - 4, v4
    v_mov_b32 v7, s41
    v_add_co_u32 v6, vcc, s40, v4
    s_nop 1
    v_addc_co_u32 v7, vcc, 0, v7, vcc
    v_cmp_gt_u32 vcc, 16, v0
    s_and_saveexec_b64 s[70:71], vcc
    s_cbranch_execz L_nopf
    global_load_dword v71, v[6:7], off
L_nopf:
    s_mov_b64 exec, s[70:71]
    v_lshrrev_b32 v4, 6, v0
    v_and_b32 v1, 63, v0
    v_readfirstlane_b32 s56, v4
    v_and_b32 v2, 15, v0
    v_bfe_u32 v3, v0, 4, 2
    s_and_b32 s62, s2, 7
    s_lshr_b32 s63, s2, 3
    s_mul_i32 s3, s63, 43
    s_lshr_b32 s3, s3, 8
    s_lshl2_add_u32 s57, s62, s3
    s_mul_i32 s3, s3, 6
    s_sub_u32 s69, s63, s3
    s_lshr_b32 s59, s69, 1
    s_mov_b32 s38, 0x400000
    s_mov_b32 s39, 0x20000
    s_lshl_b32 s68, s56, 14
    s_add_u32 s68, s68, 0x4000
    s_mov_b32 s61, 0
    s_cmp_lt_u32 s63, 24
    s_cbranch_scc1 L_is_a
    s_lshl3_add_u32 s69, s62, s63
    s_sub_u32 s69, s69, 24
    s_lshr_b32 s57, s69, 1
    s_lshl_b32 s68, s56, 13
    s_bitset1_b32 s68, 17
    s_bitset1_b32 s61, 18
    s_mov_b32 s59, 0
L_is_a:
    s_and_b32 s58, s69, 1
    s_lshl_b32 s62, s57, 8
    s_cmp_lg_u32 s59, 0
    s_cbranch_scc1 L_role_a1
    s_lshl2_add_u32 s3, s58, s56
    s_lshl_b32 s3, s3, 19
    s_add_u32 s61, s61, s3
    s_add_u32 s61, s61, s62
    v_xor_b32 v4, v3, v2
    v_lshlrev_b32 v5, 13, v3
    v_lshl_add_u32 v36, v4, 4, v5
    v_xor_b32 v37, 64, v36
    v_xor_b32 v38, 0x80, v36
    v_xor_b32 v39, 64, v38
    s_mov_b32 m0, s68
    s_movk_i32 s65, 0x400
    s_lshl_b32 s66, s65, 5
    s_waitcnt lgkmcnt(0)
    s_mov_b32 s36, s24
    s_and_b32 s37, s25, 0xffff
    buffer_load_dwordx4 v36, s[36:39], s61 offen  lds
    s_add_u32 m0, m0, s65
    s_add_u32 s61, s61, s66
    buffer_load_dwordx4 v37, s[36:39], s61 offen  lds
    s_add_u32 m0, m0, s65
    s_add_u32 s61, s61, s66
    buffer_load_dwordx4 v38, s[36:39], s61 offen  lds
    s_add_u32 m0, m0, s65
    s_add_u32 s61, s61, s66
    buffer_load_dwordx4 v39, s[36:39], s61 offen  lds
    s_add_u32 m0, m0, s65
    s_add_u32 s61, s61, s66
    buffer_load_dwordx4 v36, s[36:39], s61 offen  lds
    s_add_u32 m0, m0, s65
    s_add_u32 s61, s61, s66
    buffer_load_dwordx4 v37, s[36:39], s61 offen  lds
    s_add_u32 m0, m0, s65
    s_add_u32 s61, s61, s66
    buffer_load_dwordx4 v38, s[36:39], s61 offen  lds
    s_add_u32 m0, m0, s65
    s_add_u32 s61, s61, s66
    buffer_load_dwordx4 v39, s[36:39], s61 offen  lds
    s_add_u32 m0, m0, s65
    s_add_u32 s61, s61, s66
    s_load_dword s60, s[34:35], 0
    s_cmp_lt_u32 s63, 24
    s_cbranch_scc1 L_role_a2
    s_branch L_role_b
L_role_a1:
    s_sub_u32 s69, s69, 2
    s_lshl2_add_u32 s3, s69, s56
    s_lshl_b32 s61, s3, 18
    s_add_u32 s61, s61, s62
    v_lshlrev_b32 v36, 16, v3
    v_lshl_add_u32 v36, v2, 4, v36
    s_xor_b32 s68, s61, 512
    s_movk_i32 s65, 0x2000
    s_waitcnt lgkmcnt(0)
    s_mov_b32 s36, s22
    s_and_b32 s37, s23, 0xffff
    buffer_load_dwordx4 a[192:195], v36, s[36:39], s61 offen nt
    s_add_u32 s61, s61, s65
    buffer_load_dwordx4 a[196:199], v36, s[36:39], s61 offen nt
    s_add_u32 s61, s61, s65
    buffer_load_dwordx4 a[200:203], v36, s[36:39], s61 offen nt
    s_add_u32 s61, s61, s65
    buffer_load_dwordx4 a[204:207], v36, s[36:39], s61 offen nt
    s_add_u32 s61, s61, s65
    buffer_load_dwordx4 a[208:211], v36, s[36:39], s61 offen nt
    s_add_u32 s61, s61, s65
    buffer_load_dwordx4 a[212:215], v36, s[36:39], s61 offen nt
    s_add_u32 s61, s61, s65
    buffer_load_dwordx4 a[216:219], v36, s[36:39], s61 offen nt
    s_add_u32 s61, s61, s65
    buffer_load_dwordx4 a[220:223], v36, s[36:39], s61 offen nt
    s_load_dword s60, s[34:35], 0
    s_lshl_b32 s3, s3, 6
    v_lshrrev_b32 v4, 3, v2
    v_lshlrev_b32 v4, 10, v4
    v_lshl_add_u32 v4, v3, 4, v4
    v_add_u32 v4, s3, v4
    global_load_dwordx4 v[248:251], v4, s[18:19]
    global_load_dwordx4 v[252:255], v4, s[8:9]
    s_mov_b32 s40, s14
    s_and_b32 s41, s15, 0xffff
    s_mov_b32 s42, 4194304
    s_mov_b32 s43, 0x20000
    v_mov_b32 v6, 0
    v_mov_b32 v7, 0
    ds_write_b64 v6, v[6:7] offset:13312
    ds_write_b64 v6, v[6:7] offset:13320
    s_lshl_b32 s3, s58, 5
    s_add_u32 s3, s3, s57
    s_lshl_b32 s3, s3, 21
    s_mul_i32 s62, s59, 176128
    s_add_u32 s3, s3, s62
    s_add_u32 s3, s3, 1568768
    s_add_u32 s52, s10, s3
    s_addc_u32 s53, s11, 0
    s_and_b32 s53, s53, 0xffff
    s_mov_b32 s54, 176128
    s_mov_b32 s55, 0x20000
    s_add_u32 s4, s12, s3
    s_addc_u32 s5, s13, 0
    s_and_b32 s5, s5, 0xffff
    s_mov_b32 s6, 176128
    s_mov_b32 s7, 0x20000
    s_mov_b32 s48, s34
    s_and_b32 s49, s35, 0xffff
    s_mov_b32 s50, 4194304
    s_mov_b32 s51, 0x20000
    s_mov_b32 s64, 1000000
    s_movk_i32 s65, 0xfff
    s_mov_b32 s66, 0xfffff000
    s_mov_b32 s67, 0x3fb8aa3b
    v_lshlrev_b32 v22, 4, v1
    s_lshl_b32 s3, s56, 10
    v_add_u32 v0, s3, v22
    v_and_b32 v4, 1, v2
    v_bfe_u32 v5, v2, 1, 2
    v_cmp_eq_u32 vcc, 1, v4
    v_mov_b32 v6, 0xffff
    v_mov_b32 v7, 0xffff0000
    v_cndmask_b32 v8, v6, v7, vcc
    v_mov_b32 v6, 0x0c0c0100
    v_mov_b32 v7, 0x01000c0c
    v_cndmask_b32 v24, v6, v7, vcc
    v_mov_b32 v6, 0x0c0c0302
    v_mov_b32 v7, 0x03020c0c
    v_cndmask_b32 v25, v6, v7, vcc
    v_mov_b32 v6, 0x0c0c0c0c
    v_cmp_eq_u32 vcc, 0, v5
    s_nop 1
    v_cndmask_b32 v10, 0, v8, vcc
    v_cndmask_b32 v14, v6, v24, vcc
    v_cndmask_b32 v15, v6, v25, vcc
    v_cmp_eq_u32 vcc, 1, v5
    s_nop 1
    v_cndmask_b32 v11, 0, v8, vcc
    v_cndmask_b32 v16, v6, v24, vcc
    v_cndmask_b32 v17, v6, v25, vcc
    v_cmp_eq_u32 vcc, 2, v5
    s_nop 1
    v_cndmask_b32 v12, 0, v8, vcc
    v_cndmask_b32 v18, v6, v24, vcc
    v_cndmask_b32 v19, v6, v25, vcc
    v_cmp_eq_u32 vcc, 3, v5
    s_nop 1
    v_cndmask_b32 v13, 0, v8, vcc
    v_cndmask_b32 v20, v6, v24, vcc
    v_cndmask_b32 v21, v6, v25, vcc
    s_waitcnt lgkmcnt(0)
    s_add_u32 s60, s60, 1
    v_mov_b32 v9, s60
    s_mov_b32 s0, 0
    s_cmp_lg_u32 s56, 3
    s_cbranch_scc1 L_noid_1
    s_getreg_b32 s3, hwreg(HW_REG_XCC_ID, 0, 4)
    s_xor_b32 s3, s3, s60
    v_mov_b32 v4, s3
    v_mov_b32 v5, s60
    s_and_b32 s3, s2, 7
    s_lshl_b32 s3, s3, 5
    s_lshr_b32 s0, s2, 3
    s_add_u32 s3, s3, s0
    s_lshl_b32 s3, s3, 3
    s_add_u32 s3, s3, 4096
    s_mov_b32 s0, 0
    v_mov_b32 v6, 0
    s_mov_b64 exec, 1
    buffer_store_dwordx2 v[4:5], v6, s[48:51], s3 offen
    s_mov_b64 exec, -1
L_noid_1:
    s_barrier
    s_mov_b32 s70, 0
    s_waitcnt vmcnt(7)
    s_lshr_b32 s3, s57, 1
    s_lshl2_add_u32 s63, s3, s69
    s_lshl_b32 s62, s63, 18
    s_mul_i32 s63, s63, 0
    s_and_b32 s3, s57, 1
    s_add_u32 s63, s63, s3
    s_add_u32 s63, s63, 22
    s_and_b32 s63, s63, 63
    s_lshl_b32 s63, s63, 12
    s_add_u32 s36, s20, s62
    s_addc_u32 s37, s21, 0
    s_and_b32 s37, s37, 0xffff
    s_mov_b32 s38, 262144
    s_mov_b32 s39, 0x20000
    buffer_load_dwordx4 a[188:191], v0, s[36:39], s63 offen
    s_addk_i32 s63, 0x2000
    s_bitset0_b32 s63, 18
    s_waitcnt vmcnt(7)
    buffer_load_dwordx4 a[188:191], v0, s[36:39], s63 offen
    s_addk_i32 s63, 0x2000
    s_bitset0_b32 s63, 18
    s_waitcnt vmcnt(7)
    buffer_load_dwordx4 a[188:191], v0, s[36:39], s63 offen
    s_addk_i32 s63, 0x2000
    s_bitset0_b32 s63, 18
    s_waitcnt vmcnt(7)
    buffer_load_dwordx4 a[188:191], v0, s[36:39], s63 offen
    s_addk_i32 s63, 0x2000
    s_bitset0_b32 s63, 18
    s_waitcnt vmcnt(7)
    buffer_load_dwordx4 a[188:191], v0, s[36:39], s63 offen
    s_addk_i32 s63, 0x2000
    s_bitset0_b32 s63, 18
    s_waitcnt vmcnt(7)
    buffer_load_dwordx4 a[188:191], v0, s[36:39], s63 offen
    s_addk_i32 s63, 0x2000
    s_bitset0_b32 s63, 18
    s_waitcnt vmcnt(7)
    buffer_load_dwordx4 a[188:191], v0, s[36:39], s63 offen
    s_addk_i32 s63, 0x2000
    s_bitset0_b32 s63, 18
    v_perm_b32 v24, v248, v248, v14
    v_perm_b32 v25, v248, v248, v16
    v_perm_b32 v26, v248, v248, v18
    v_perm_b32 v27, v248, v248, v20
    v_perm_b32 v28, v248, v248, v15
    v_perm_b32 v29, v248, v248, v17
    v_perm_b32 v30, v248, v248, v19
    v_perm_b32 v31, v248, v248, v21
    v_mfma_f32_16x16x32_bf16 v[32:35], v[24:27], a[192:195], 0
    v_perm_b32 v24, v249, v249, v14
    v_perm_b32 v25, v249, v249, v16
    v_perm_b32 v26, v249, v249, v18
    v_perm_b32 v27, v249, v249, v20
    v_mfma_f32_16x16x32_bf16 v[32:35], v[28:31], a[196:199], v[32:35]
    v_perm_b32 v28, v249, v249, v15
    v_perm_b32 v29, v249, v249, v17
    v_perm_b32 v30, v249, v249, v19
    v_perm_b32 v31, v249, v249, v21
    v_mfma_f32_16x16x32_bf16 v[32:35], v[24:27], a[200:203], v[32:35]
    v_perm_b32 v24, v250, v250, v14
    v_perm_b32 v25, v250, v250, v16
    v_perm_b32 v26, v250, v250, v18
    v_perm_b32 v27, v250, v250, v20
    v_mfma_f32_16x16x32_bf16 v[32:35], v[28:31], a[204:207], v[32:35]
    v_perm_b32 v28, v250, v250, v15
    v_perm_b32 v29, v250, v250, v17
    v_perm_b32 v30, v250, v250, v19
    v_perm_b32 v31, v250, v250, v21
    v_mfma_f32_16x16x32_bf16 v[32:35], v[24:27], a[208:211], v[32:35]
    v_perm_b32 v24, v251, v251, v14
    v_perm_b32 v25, v251, v251, v16
    v_perm_b32 v26, v251, v251, v18
    v_perm_b32 v27, v251, v251, v20
    v_mfma_f32_16x16x32_bf16 v[32:35], v[28:31], a[212:215], v[32:35]
    v_perm_b32 v28, v251, v251, v15
    v_perm_b32 v29, v251, v251, v17
    v_perm_b32 v30, v251, v251, v19
    v_perm_b32 v31, v251, v251, v21
    v_mfma_f32_16x16x32_bf16 v[32:35], v[24:27], a[216:219], v[32:35]
    s_nop 0
    v_mfma_f32_16x16x32_bf16 v[32:35], v[28:31], a[220:223], v[32:35]
    s_nop 7
    ds_write_b128 v0, v[32:35] offset:0
    v_mov_b32 v4, 0
    v_mov_b32 v5, 1
    s_mov_b64 exec, 1
    ds_add_rtn_u32 v5, v4, v5 offset:13316
    s_mov_b64 exec, -1
    s_waitcnt lgkmcnt(0)
    v_readfirstlane_b32 s3, v5
    s_cmp_lg_u32 s3, 3
    s_cbranch_scc1 L_nopub_2
    ds_read_b128 v[56:59], v22 offset:0
    ds_read_b128 v[60:63], v22 offset:1024
    ds_read_b128 v[64:67], v22 offset:2048
    ds_read_b128 v[68:71], v22 offset:3072
    s_xor_b32 s3, s57, 0
    s_lshl_b32 s3, s3, 2
    s_add_u32 s3, s3, s69
    s_lshl_b32 s3, s3, 10
    s_add_u32 s3, s3, 196608
    s_waitcnt lgkmcnt(0)
    v_add_f32 v56, v56, v60
    v_add_f32 v64, v64, v68
    v_add_f32 v57, v57, v61
    v_add_f32 v65, v65, v69
    v_add_f32 v58, v58, v62
    v_add_f32 v66, v66, v70
    v_add_f32 v59, v59, v63
    v_add_f32 v67, v67, v71
    v_add_f32 v248, v56, v64
    v_add_f32 v249, v57, v65
    v_add_f32 v250, v58, v66
    v_add_f32 v251, v59, v67
    v_add_u32 v248, 0x800, v248
    v_add_u32 v249, 0x800, v249
    v_add_u32 v250, 0x800, v250
    v_add_u32 v251, 0x800, v251
    v_bfi_b32 v248, s65, v9, v248
    v_bfi_b32 v249, s65, v9, v249
    v_bfi_b32 v250, s65, v9, v250
    v_bfi_b32 v251, s65, v9, v251
    buffer_store_dwordx4 v[248:251], v22, s[48:51], s3 offen
    s_mov_b32 s70, 1
    s_mov_b32 s71, s3
    s_nop 1
L_nopub_2:
    s_waitcnt vmcnt(7)
    buffer_load_dwordx4 a[188:191], v0, s[36:39], s63 offen
    s_addk_i32 s63, 0x2000
    s_bitset0_b32 s63, 18
    s_waitcnt vmcnt(7)
    buffer_load_dwordx4 a[188:191], v0, s[36:39], s63 offen
    s_addk_i32 s63, 0x2000
    s_bitset0_b32 s63, 18
    s_waitcnt vmcnt(7)
    buffer_load_dwordx4 a[188:191], v0, s[36:39], s63 offen
    s_addk_i32 s63, 0x2000
    s_bitset0_b32 s63, 18
    s_waitcnt vmcnt(7)
    buffer_load_dwordx4 a[188:191], v0, s[36:39], s63 offen
    s_addk_i32 s63, 0x2000
    s_bitset0_b32 s63, 18
    s_waitcnt vmcnt(7)
    buffer_load_dwordx4 a[188:191], v0, s[36:39], s63 offen
    s_addk_i32 s63, 0x2000
    s_bitset0_b32 s63, 18
    s_waitcnt vmcnt(7)
    buffer_load_dwordx4 a[188:191], v0, s[36:39], s63 offen
    s_addk_i32 s63, 0x2000
    s_bitset0_b32 s63, 18
    s_waitcnt vmcnt(7)
    buffer_load_dwordx4 a[188:191], v0, s[36:39], s63 offen
    s_addk_i32 s63, 0x2000
    s_bitset0_b32 s63, 18
    s_waitcnt vmcnt(7)
    buffer_load_dwordx4 a[188:191], v0, s[36:39], s63 offen
    s_addk_i32 s63, 0x2000
    s_bitset0_b32 s63, 18
    s_waitcnt vmcnt(7)
    buffer_load_dwordx4 a[188:191], v0, s[36:39], s63 offen
    s_addk_i32 s63, 0x2000
    s_bitset0_b32 s63, 18
    s_waitcnt vmcnt(7)
    buffer_load_dwordx4 a[188:191], v0, s[36:39], s63 offen
    s_addk_i32 s63, 0x2000
    s_bitset0_b32 s63, 18
    s_waitcnt vmcnt(7)
    buffer_load_dwordx4 a[188:191], v0, s[36:39], s63 offen
    s_addk_i32 s63, 0x2000
    s_bitset0_b32 s63, 18
    s_waitcnt vmcnt(7)
    buffer_load_dwordx4 a[188:191], v0, s[36:39], s63 offen
    s_addk_i32 s63, 0x2000
    s_bitset0_b32 s63, 18
    s_waitcnt vmcnt(7)
    s_xor_b32 s3, s57, 2
    s_lshl2_add_u32 s3, s3, s69
    s_lshl_b32 s3, s3, 10
    s_add_u32 s3, s3, 65536
    s_cmp_lg_u32 s56, 0
    s_cbranch_scc1 L_nowarm_3
    v_min_u32 v4, 7, v1
    v_lshlrev_b32 v4, 7, v4
    buffer_load_dword a188, v4, s[48:51], s3 offen
L_nowarm_3:
    buffer_load_dwordx4 a[188:191], v0, s[36:39], s63 offen
    s_addk_i32 s63, 0x2000
    s_bitset0_b32 s63, 18
    s_waitcnt vmcnt(7)
    s_bitcmp1_b32 s57, 0
    s_cbranch_scc1 L_odd_4
    s_waitcnt vmcnt(7)
    buffer_load_dwordx4 a[188:191], v0, s[36:39], s63 offen
    s_addk_i32 s63, 0x1000
    s_bitset0_b32 s63, 18
    s_waitcnt vmcnt(7)
    buffer_load_dwordx4 a[188:191], v0, s[36:39], s63 offen
    s_addk_i32 s63, 0x1000
    s_bitset0_b32 s63, 18
L_odd_4:
    buffer_load_dwordx4 a[224:227], v36, s[40:43], s68 offen nt
    s_add_u32 s68, s68, 0x2000
    s_waitcnt vmcnt(7)
    buffer_load_dwordx4 a[228:231], v36, s[40:43], s68 offen nt
    s_add_u32 s68, s68, 0x2000
    s_waitcnt vmcnt(7)
    buffer_load_dwordx4 a[232:235], v36, s[40:43], s68 offen nt
    s_add_u32 s68, s68, 0x2000
    s_waitcnt vmcnt(7)
    buffer_load_dwordx4 a[236:239], v36, s[40:43], s68 offen nt
    s_add_u32 s68, s68, 0x2000
    s_waitcnt vmcnt(7)
    buffer_load_dwordx4 a[240:243], v36, s[40:43], s68 offen nt
    s_add_u32 s68, s68, 0x2000
    s_waitcnt vmcnt(7)
    buffer_load_dwordx4 a[244:247], v36, s[40:43], s68 offen nt
    s_add_u32 s68, s68, 0x2000
    s_waitcnt vmcnt(7)
    buffer_load_dwordx4 a[248:251], v36, s[40:43], s68 offen nt
    s_add_u32 s68, s68, 0x2000
    s_waitcnt vmcnt(7)
    buffer_load_dwordx4 a[252:255], v36, s[40:43], s68 offen nt
    s_and_b32 s3, s2, 7
    s_lshl_b32 s3, s3, 8
    s_add_u32 s3, s3, 4096
    v_and_b32 v4, 31, v1
    v_lshlrev_b32 v4, 3, v4
    buffer_load_dwordx2 v[40:41], v4, s[48:51], s3 offen sc1
    s_waitcnt vmcnt(7)
    s_mov_b32 s10, 0
    buffer_load_dwordx4 v[72:75], v0, s[52:55], s10 offen nt
    s_waitcnt vmcnt(7)
    s_mov_b32 s10, 4096
    buffer_load_dwordx4 v[76:79], v0, s[52:55], s10 offen nt
    s_waitcnt vmcnt(7)
    s_mov_b32 s10, 8192
    buffer_load_dwordx4 v[80:83], v0, s[52:55], s10 offen nt
    s_waitcnt vmcnt(7)
    s_mov_b32 s10, 12288
    buffer_load_dwordx4 v[84:87], v0, s[52:55], s10 offen nt
    s_waitcnt vmcnt(7)
    s_mov_b32 s10, 16384
    buffer_load_dwordx4 v[88:91], v0, s[52:55], s10 offen nt
    s_waitcnt vmcnt(7)
    s_mov_b32 s10, 20480
    buffer_load_dwordx4 v[92:95], v0, s[52:55], s10 offen nt
    s_waitcnt vmcnt(7)
    s_mov_b32 s10, 24576
    buffer_load_dwordx4 v[96:99], v0, s[52:55], s10 offen nt
    v_perm_b32 v24, v252, v252, v14
    v_perm_b32 v25, v252, v252, v16
    v_perm_b32 v26, v252, v252, v18
    v_perm_b32 v27, v252, v252, v20
    v_perm_b32 v28, v252, v252, v15
    v_perm_b32 v29, v252, v252, v17
    v_perm_b32 v30, v252, v252, v19
    v_perm_b32 v31, v252, v252, v21
    v_mfma_f32_16x16x32_bf16 v[32:35], v[24:27], a[224:227], 0
    v_perm_b32 v24, v253, v253, v14
    v_perm_b32 v25, v253, v253, v16
    v_perm_b32 v26, v253, v253, v18
    v_perm_b32 v27, v253, v253, v20
    v_mfma_f32_16x16x32_bf16 v[32:35], v[28:31], a[228:231], v[32:35]
    v_perm_b32 v28, v253, v253, v15
    v_perm_b32 v29, v253, v253, v17
    v_perm_b32 v30, v253, v253, v19
    v_perm_b32 v31, v253, v253, v21
    v_mfma_f32_16x16x32_bf16 v[32:35], v[24:27], a[232:235], v[32:35]
    v_perm_b32 v24, v254, v254, v14
    v_perm_b32 v25, v254, v254, v16
    v_perm_b32 v26, v254, v254, v18
    v_perm_b32 v27, v254, v254, v20
    v_mfma_f32_16x16x32_bf16 v[32:35], v[28:31], a[236:239], v[32:35]
    v_perm_b32 v28, v254, v254, v15
    v_perm_b32 v29, v254, v254, v17
    v_perm_b32 v30, v254, v254, v19
    v_perm_b32 v31, v254, v254, v21
    v_mfma_f32_16x16x32_bf16 v[32:35], v[24:27], a[240:243], v[32:35]
    v_perm_b32 v24, v255, v255, v14
    v_perm_b32 v25, v255, v255, v16
    v_perm_b32 v26, v255, v255, v18
    v_perm_b32 v27, v255, v255, v20
    v_mfma_f32_16x16x32_bf16 v[32:35], v[28:31], a[244:247], v[32:35]
    v_perm_b32 v28, v255, v255, v15
    v_perm_b32 v29, v255, v255, v17
    v_perm_b32 v30, v255, v255, v19
    v_perm_b32 v31, v255, v255, v21
    v_mfma_f32_16x16x32_bf16 v[32:35], v[24:27], a[248:251], v[32:35]
    s_nop 0
    v_mfma_f32_16x16x32_bf16 v[32:35], v[28:31], a[252:255], v[32:35]
    s_nop 7
    ds_write_b128 v0, v[32:35] offset:4096
    s_waitcnt vmcnt(7)
    s_getreg_b32 s3, hwreg(HW_REG_XCC_ID, 0, 4)
    s_xor_b32 s3, s3, s60
    v_xor_b32 v4, s3, v40
    v_bitop3_b32 v4, v4, v41, s60 bitop3:0xf6
    v_cmp_ne_u32 vcc, 0, v4
    s_cmp_eq_u64 vcc, 0
    s_cselect_b32 s0, 1, 0
    s_cmp_le_u32 s70, s0
    s_cbranch_scc1 L_nolate_5
    buffer_store_dwordx4 v[248:251], v22, s[48:51], s71 offen sc1
L_nolate_5:
    v_mov_b32 v4, 0
    v_mov_b32 v5, 1
    s_mov_b64 exec, 1
    ds_add_rtn_u32 v5, v4, v5 offset:13312
    s_mov_b64 exec, -1
    s_waitcnt lgkmcnt(0)
    v_readfirstlane_b32 s3, v5
    s_cmp_lg_u32 s3, 3
    s_cbranch_scc1 L_nopub_6
    ds_read_b128 v[56:59], v22 offset:4096
    ds_read_b128 v[60:63], v22 offset:5120
    ds_read_b128 v[64:67], v22 offset:6144
    ds_read_b128 v[68:71], v22 offset:7168
    s_xor_b32 s3, s57, 2
    s_lshl_b32 s3, s3, 2
    s_add_u32 s3, s3, s69
    s_lshl_b32 s3, s3, 10
    s_add_u32 s3, s3, 65536
    s_waitcnt lgkmcnt(0)
    v_add_f32 v56, v56, v60
    v_add_f32 v64, v64, v68
    v_add_f32 v57, v57, v61
    v_add_f32 v65, v65, v69
    v_add_f32 v58, v58, v62
    v_add_f32 v66, v66, v70
    v_add_f32 v59, v59, v63
    v_add_f32 v67, v67, v71
    v_add_f32 v252, v56, v64
    v_add_f32 v253, v57, v65
    v_add_f32 v254, v58, v66
    v_add_f32 v255, v59, v67
    v_add_u32 v252, 0x800, v252
    v_add_u32 v253, 0x800, v253
    v_add_u32 v254, 0x800, v254
    v_add_u32 v255, 0x800, v255
    v_bfi_b32 v252, s65, v9, v252
    v_bfi_b32 v253, s65, v9, v253
    v_bfi_b32 v254, s65, v9, v254
    v_bfi_b32 v255, s65, v9, v255
    s_cmp_eq_u32 s0, 0
    s_cbranch_scc1 L_far_7
    buffer_store_dwordx4 v[252:255], v22, s[48:51], s3 offen
    s_branch L_join_8
L_far_7:
    buffer_store_dwordx4 v[252:255], v22, s[48:51], s3 offen sc1
L_join_8:
    s_nop 1
    s_nop 1
L_nopub_6:
    s_mov_b32 s10, 28672
    buffer_load_dwordx4 v[100:103], v0, s[52:55], s10 offen nt
    s_waitcnt vmcnt(7)
    s_mov_b32 s10, 32768
    buffer_load_dwordx4 v[104:107], v0, s[52:55], s10 offen nt
    s_waitcnt vmcnt(7)
    s_mov_b32 s10, 36864
    buffer_load_dwordx4 v[108:111], v0, s[52:55], s10 offen nt
    s_waitcnt vmcnt(7)
    s_mov_b32 s10, 40960
    buffer_load_dwordx4 v[112:115], v0, s[52:55], s10 offen nt
    s_waitcnt vmcnt(7)
    s_mov_b32 s10, 45056
    buffer_load_dwordx4 v[116:119], v0, s[52:55], s10 offen nt
    s_waitcnt vmcnt(7)
    s_mov_b32 s10, 49152
    buffer_load_dwordx4 v[120:123], v0, s[52:55], s10 offen nt
    s_waitcnt vmcnt(7)
    s_mov_b32 s10, 53248
    buffer_load_dwordx4 v[124:127], v0, s[52:55], s10 offen nt
    s_and_b32 s3, s2, 7
    s_lshl_b32 s3, s3, 8
    s_add_u32 s3, s3, 4096
    v_and_b32 v4, 31, v1
    v_lshlrev_b32 v4, 3, v4
    buffer_load_dwordx2 v[40:41], v4, s[48:51], s3 offen sc1
    s_lshl_b32 s68, s57, 12
    s_add_u32 s68, s68, 65536
    buffer_load_dwordx4 v[56:59], v22, s[48:51], s68 offen offset:0 sc1
    buffer_load_dwordx4 v[60:63], v22, s[48:51], s68 offen offset:1024 sc1
    buffer_load_dwordx4 v[64:67], v22, s[48:51], s68 offen offset:2048 sc1
    buffer_load_dwordx4 v[68:71], v22, s[48:51], s68 offen offset:3072 sc1
    s_mov_b32 s10, 57344
    buffer_load_dwordx4 v[128:131], v0, s[52:55], s10 offen nt
    s_mov_b32 s10, 61440
    buffer_load_dwordx4 v[132:135], v0, s[52:55], s10 offen nt
    s_mov_b32 s10, 65536
    buffer_load_dwordx4 v[136:139], v0, s[52:55], s10 offen nt
    s_mov_b32 s10, 69632
    buffer_load_dwordx4 v[140:143], v0, s[52:55], s10 offen nt
    s_mov_b32 s10, 73728
    buffer_load_dwordx4 v[144:147], v0, s[52:55], s10 offen nt
    s_mov_b32 s10, 77824
    buffer_load_dwordx4 v[148:151], v0, s[52:55], s10 offen nt
    s_mov_b32 s10, 81920
    buffer_load_dwordx4 v[152:155], v0, s[52:55], s10 offen nt
    s_mov_b32 s10, 86016
    buffer_load_dwordx4 v[156:159], v0, s[52:55], s10 offen nt
    s_mov_b32 s10, 90112
    buffer_load_dwordx4 v[160:163], v0, s[52:55], s10 offen nt
    s_mov_b32 s10, 94208
    buffer_load_dwordx4 v[164:167], v0, s[52:55], s10 offen nt
    s_mov_b32 s10, 98304
    buffer_load_dwordx4 v[168:171], v0, s[52:55], s10 offen nt
    s_mov_b32 s10, 102400
    buffer_load_dwordx4 v[172:175], v0, s[52:55], s10 offen nt
    s_mov_b32 s10, 106496
    buffer_load_dwordx4 v[176:179], v0, s[52:55], s10 offen nt
    s_mov_b32 s10, 110592
    buffer_load_dwordx4 v[180:183], v0, s[52:55], s10 offen nt
    s_waitcnt vmcnt(14)
L_chk_9:
    v_xor_b32 v4, s60, v56
    v_bitop3_b32 v4, v4, v57, s60 bitop3:0xf6
    v_bitop3_b32 v4, v4, v58, s60 bitop3:0xf6
    v_bitop3_b32 v4, v4, v59, s60 bitop3:0xf6
    v_bitop3_b32 v4, v4, v60, s60 bitop3:0xf6
    v_bitop3_b32 v4, v4, v61, s60 bitop3:0xf6
    v_bitop3_b32 v4, v4, v62, s60 bitop3:0xf6
    v_bitop3_b32 v4, v4, v63, s60 bitop3:0xf6
    v_bitop3_b32 v4, v4, v64, s60 bitop3:0xf6
    v_bitop3_b32 v4, v4, v65, s60 bitop3:0xf6
    v_bitop3_b32 v4, v4, v66, s60 bitop3:0xf6
    v_bitop3_b32 v4, v4, v67, s60 bitop3:0xf6
    v_bitop3_b32 v4, v4, v68, s60 bitop3:0xf6
    v_bitop3_b32 v4, v4, v69, s60 bitop3:0xf6
    v_bitop3_b32 v4, v4, v70, s60 bitop3:0xf6
    v_bitop3_b32 v4, v4, v71, s60 bitop3:0xf6
    v_and_b32 v4, s65, v4
    v_cmp_ne_u32 vcc, 0, v4
    s_cbranch_vccz L_ok_10
    s_cmp_eq_u32 s64, 0
    s_cbranch_scc1 L_ok_10
    s_sub_u32 s64, s64, 1
    buffer_load_dwordx4 v[56:59], v22, s[48:51], s68 offen offset:0 sc1
    buffer_load_dwordx4 v[60:63], v22, s[48:51], s68 offen offset:1024 sc1
    buffer_load_dwordx4 v[64:67], v22, s[48:51], s68 offen offset:2048 sc1
    buffer_load_dwordx4 v[68:71], v22, s[48:51], s68 offen offset:3072 sc1
    s_waitcnt vmcnt(0)
    s_branch L_chk_9
L_ok_10:
    s_getreg_b32 s3, hwreg(HW_REG_XCC_ID, 0, 4)
    s_xor_b32 s3, s3, s60
    v_xor_b32 v4, s3, v40
    v_bitop3_b32 v4, v4, v41, s60 bitop3:0xf6
    v_cmp_ne_u32 vcc, 0, v4
    s_cmp_eq_u64 vcc, 0
    s_cselect_b32 s0, 1, 0
    v_and_b32 v56, s66, v56
    v_and_b32 v57, s66, v57
    v_and_b32 v58, s66, v58
    v_and_b32 v59, s66, v59
    v_and_b32 v60, s66, v60
    v_and_b32 v61, s66, v61
    v_and_b32 v62, s66, v62
    v_and_b32 v63, s66, v63
    v_and_b32 v64, s66, v64
    v_and_b32 v65, s66, v65
    v_and_b32 v66, s66, v66
    v_and_b32 v67, s66, v67
    v_and_b32 v68, s66, v68
    v_and_b32 v69, s66, v69
    v_and_b32 v70, s66, v70
    v_and_b32 v71, s66, v71
    v_add_f32 v56, v56, v60
    v_add_f32 v64, v64, v68
    v_add_f32 v57, v57, v61
    v_add_f32 v65, v65, v69
    v_add_f32 v58, v58, v62
    v_add_f32 v66, v66, v70
    v_add_f32 v59, v59, v63
    v_add_f32 v67, v67, v71
    v_add_f32 v56, v56, v64
    v_add_f32 v57, v57, v65
    v_add_f32 v58, v58, v66
    v_add_f32 v59, v59, v67
    v_cvt_pk_bf16_f32 v56, v56, v57
    v_cvt_pk_bf16_f32 v57, v58, v59
    s_lshl_b32 s3, s56, 9
    s_add_u32 s3, s3, 8192
    v_lshrrev_b32 v4, 1, v3
    v_and_b32 v6, 1, v3
    v_lshlrev_b32 v4, 8, v4
    v_lshl_add_u32 v4, v6, 3, v4
    v_lshl_add_u32 v4, v2, 4, v4
    v_add_u32 v4, s3, v4
    ds_write_b64 v4, v[56:57]
    s_lshl_b32 s62, s58, 8
    s_add_u32 s3, s3, s62
    v_lshl_add_u32 v4, v2, 4, s3
    s_waitcnt lgkmcnt(0)
    ds_read_b128 v[36:39], v4
    s_waitcnt lgkmcnt(0)
    s_mov_b32 s10, 114688
    buffer_load_dwordx4 v[184:187], v0, s[52:55], s10 offen nt
    s_mov_b32 s10, 118784
    buffer_load_dwordx4 v[188:191], v0, s[52:55], s10 offen nt
    v_dot2_f32_bf16 v40, v72, v36, 0
    v_dot2_f32_bf16 v41, v76, v36, 0
    v_dot2_f32_bf16 v42, v80, v36, 0
    v_dot2_f32_bf16 v43, v84, v36, 0
    v_dot2c_f32_bf16 v40, v73, v37
    v_dot2c_f32_bf16 v41, v77, v37
    v_dot2c_f32_bf16 v42, v81, v37
    v_dot2c_f32_bf16 v43, v85, v37
    v_dot2c_f32_bf16 v40, v74, v38
    v_dot2c_f32_bf16 v41, v78, v38
    v_dot2c_f32_bf16 v42, v82, v38
    v_dot2c_f32_bf16 v43, v86, v38
    v_dot2c_f32_bf16 v40, v75, v39
    v_dot2c_f32_bf16 v41, v79, v39
    v_dot2c_f32_bf16 v42, v83, v39
    v_dot2c_f32_bf16 v43, v87, v39
    v_add_f32_dpp v40, v40, v40 row_ror:8 row_mask:0xf bank_mask:0x3
    v_add_f32_dpp v41, v41, v41 row_ror:8 row_mask:0xf bank_mask:0x3
    s_nop 0
    v_add_f32_dpp v40, v42, v42 row_ror:8 row_mask:0xf bank_mask:0xc
    v_add_f32_dpp v41, v43, v43 row_ror:8 row_mask:0xf bank_mask:0xc
    s_nop 0
    v_add_f32_dpp v44, v40, v40 row_shl:4 row_mask:0xf bank_mask:0x5
    s_nop 1
    v_add_f32_dpp v44, v41, v41 row_shr:4 row_mask:0xf bank_mask:0xa
    s_nop 1
    v_add_f32_dpp v44, v44, v44 quad_perm:[1,0,3,2] row_mask:0xf bank_mask:0xf
    s_nop 1
    v_add_f32_dpp v44, v44, v44 quad_perm:[2,3,0,1] row_mask:0xf bank_mask:0xf
    v_cvt_pk_bf16_f32 v44, v44, v44
    v_and_b32 v44, 0xffff0000, v44
    v_mul_f32 v44, 0x3db504f3, v44
    v_cvt_pk_bf16_f32 v44, v44, v44
    v_and_b32 v44, 0xffff0000, v44
    v_mov_b32 v8, v44
    s_mov_b32 s10, 122880
    buffer_load_dwordx4 v[192:195], v0, s[52:55], s10 offen nt
    s_waitcnt vmcnt(16)
    s_lshl1_add_u32 s3, s57, s58
    s_mul_i32 s3, s3, 3
    s_add_u32 s3, s3, s59
    s_lshl_b32 s3, s3, 10
    s_add_u32 s3, s3, 524288
    s_cmp_lg_u32 s56, 0
    s_cbranch_scc1 L_nowarm_11
    v_min_u32 v4, 4, v1
    v_lshlrev_b32 v4, 7, v4
    buffer_load_dword a188, v4, s[48:51], s3 offen
L_nowarm_11:
    v_dot2_f32_bf16 v40, v88, v36, 0
    v_dot2_f32_bf16 v41, v92, v36, 0
    v_dot2_f32_bf16 v42, v96, v36, 0
    v_dot2_f32_bf16 v43, v100, v36, 0
    v_dot2c_f32_bf16 v40, v89, v37
    v_dot2c_f32_bf16 v41, v93, v37
    v_dot2c_f32_bf16 v42, v97, v37
    v_dot2c_f32_bf16 v43, v101, v37
    v_dot2c_f32_bf16 v40, v90, v38
    v_dot2c_f32_bf16 v41, v94, v38
    v_dot2c_f32_bf16 v42, v98, v38
    v_dot2c_f32_bf16 v43, v102, v38
    v_dot2c_f32_bf16 v40, v91, v39
    v_dot2c_f32_bf16 v41, v95, v39
    v_dot2c_f32_bf16 v42, v99, v39
    v_dot2c_f32_bf16 v43, v103, v39
    v_add_f32_dpp v40, v40, v40 row_ror:8 row_mask:0xf bank_mask:0x3
    v_add_f32_dpp v41, v41, v41 row_ror:8 row_mask:0xf bank_mask:0x3
    s_nop 0
    v_add_f32_dpp v40, v42, v42 row_ror:8 row_mask:0xf bank_mask:0xc
    v_add_f32_dpp v41, v43, v43 row_ror:8 row_mask:0xf bank_mask:0xc
    s_nop 0
    v_add_f32_dpp v45, v40, v40 row_shl:4 row_mask:0xf bank_mask:0x5
    s_nop 1
    v_add_f32_dpp v45, v41, v41 row_shr:4 row_mask:0xf bank_mask:0xa
    s_nop 1
    v_add_f32_dpp v45, v45, v45 quad_perm:[1,0,3,2] row_mask:0xf bank_mask:0xf
    s_nop 1
    v_add_f32_dpp v45, v45, v45 quad_perm:[2,3,0,1] row_mask:0xf bank_mask:0xf
    v_cvt_pk_bf16_f32 v45, v45, v45
    v_and_b32 v45, 0xffff0000, v45
    v_mul_f32 v45, 0x3db504f3, v45
    v_cvt_pk_bf16_f32 v45, v45, v45
    v_and_b32 v45, 0xffff0000, v45
    v_max_f32 v8, v8, v45
    s_mov_b32 s10, 126976
    buffer_load_dwordx4 v[196:199], v0, s[52:55], s10 offen nt
    s_waitcnt vmcnt(16)
    s_mov_b32 s10, 131072
    buffer_load_dwordx4 v[200:203], v0, s[52:55], s10 offen nt
    v_dot2_f32_bf16 v40, v104, v36, 0
    v_dot2_f32_bf16 v41, v108, v36, 0
    v_dot2_f32_bf16 v42, v112, v36, 0
    v_dot2_f32_bf16 v43, v116, v36, 0
    v_dot2c_f32_bf16 v40, v105, v37
    v_dot2c_f32_bf16 v41, v109, v37
    v_dot2c_f32_bf16 v42, v113, v37
    v_dot2c_f32_bf16 v43, v117, v37
    v_dot2c_f32_bf16 v40, v106, v38
    v_dot2c_f32_bf16 v41, v110, v38
    v_dot2c_f32_bf16 v42, v114, v38
    v_dot2c_f32_bf16 v43, v118, v38
    v_dot2c_f32_bf16 v40, v107, v39
    v_dot2c_f32_bf16 v41, v111, v39
    v_dot2c_f32_bf16 v42, v115, v39
    v_dot2c_f32_bf16 v43, v119, v39
    v_add_f32_dpp v40, v40, v40 row_ror:8 row_mask:0xf bank_mask:0x3
    v_add_f32_dpp v41, v41, v41 row_ror:8 row_mask:0xf bank_mask:0x3
    s_nop 0
    v_add_f32_dpp v40, v42, v42 row_ror:8 row_mask:0xf bank_mask:0xc
    v_add_f32_dpp v41, v43, v43 row_ror:8 row_mask:0xf bank_mask:0xc
    s_nop 0
    v_add_f32_dpp v46, v40, v40 row_shl:4 row_mask:0xf bank_mask:0x5
    s_nop 1
    v_add_f32_dpp v46, v41, v41 row_shr:4 row_mask:0xf bank_mask:0xa
    s_nop 1
    v_add_f32_dpp v46, v46, v46 quad_perm:[1,0,3,2] row_mask:0xf bank_mask:0xf
    s_nop 1
    v_add_f32_dpp v46, v46, v46 quad_perm:[2,3,0,1] row_mask:0xf bank_mask:0xf
    v_cvt_pk_bf16_f32 v46, v46, v46
    v_and_b32 v46, 0xffff0000, v46
    v_mul_f32 v46, 0x3db504f3, v46
    v_cvt_pk_bf16_f32 v46, v46, v46
    v_and_b32 v46, 0xffff0000, v46
    v_max_f32 v8, v8, v46
    s_waitcnt vmcnt(16)
    s_mov_b32 s10, 135168
    buffer_load_dwordx4 v[204:207], v0, s[52:55], s10 offen nt
    s_waitcnt vmcnt(16)
    s_mov_b32 s10, 139264
    buffer_load_dwordx4 v[208:211], v0, s[52:55], s10 offen nt
    v_dot2_f32_bf16 v40, v120, v36, 0
    v_dot2_f32_bf16 v41, v124, v36, 0
    v_dot2_f32_bf16 v42, v128, v36, 0
    v_dot2_f32_bf16 v43, v132, v36, 0
    v_dot2c_f32_bf16 v40, v121, v37
    v_dot2c_f32_bf16 v41, v125, v37
    v_dot2c_f32_bf16 v42, v129, v37
    v_dot2c_f32_bf16 v43, v133, v37
    v_dot2c_f32_bf16 v40, v122, v38
    v_dot2c_f32_bf16 v41, v126, v38
    v_dot2c_f32_bf16 v42, v130, v38
    v_dot2c_f32_bf16 v43, v134, v38
    v_dot2c_f32_bf16 v40, v123, v39
    v_dot2c_f32_bf16 v41, v127, v39
    v_dot2c_f32_bf16 v42, v131, v39
    v_dot2c_f32_bf16 v43, v135, v39
    v_add_f32_dpp v40, v40, v40 row_ror:8 row_mask:0xf bank_mask:0x3
    v_add_f32_dpp v41, v41, v41 row_ror:8 row_mask:0xf bank_mask:0x3
    s_nop 0
    v_add_f32_dpp v40, v42, v42 row_ror:8 row_mask:0xf bank_mask:0xc
    v_add_f32_dpp v41, v43, v43 row_ror:8 row_mask:0xf bank_mask:0xc
    s_nop 0
    v_add_f32_dpp v47, v40, v40 row_shl:4 row_mask:0xf bank_mask:0x5
    s_nop 1
    v_add_f32_dpp v47, v41, v41 row_shr:4 row_mask:0xf bank_mask:0xa
    s_nop 1
    v_add_f32_dpp v47, v47, v47 quad_perm:[1,0,3,2] row_mask:0xf bank_mask:0xf
    s_nop 1
    v_add_f32_dpp v47, v47, v47 quad_perm:[2,3,0,1] row_mask:0xf bank_mask:0xf
    v_cvt_pk_bf16_f32 v47, v47, v47
    v_and_b32 v47, 0xffff0000, v47
    v_mul_f32 v47, 0x3db504f3, v47
    v_cvt_pk_bf16_f32 v47, v47, v47
    v_and_b32 v47, 0xffff0000, v47
    v_max_f32 v8, v8, v47
    s_waitcnt vmcnt(16)
    s_mov_b32 s10, 143360
    buffer_load_dwordx4 v[212:215], v0, s[52:55], s10 offen nt
    s_waitcnt vmcnt(16)
    s_mov_b32 s10, 147456
    buffer_load_dwordx4 v[216:219], v0, s[52:55], s10 offen nt
    v_dot2_f32_bf16 v40, v136, v36, 0
    v_dot2_f32_bf16 v41, v140, v36, 0
    v_dot2_f32_bf16 v42, v144, v36, 0
    v_dot2_f32_bf16 v43, v148, v36, 0
    v_dot2c_f32_bf16 v40, v137, v37
    v_dot2c_f32_bf16 v41, v141, v37
    v_dot2c_f32_bf16 v42, v145, v37
    v_dot2c_f32_bf16 v43, v149, v37
    v_dot2c_f32_bf16 v40, v138, v38
    v_dot2c_f32_bf16 v41, v142, v38
    v_dot2c_f32_bf16 v42, v146, v38
    v_dot2c_f32_bf16 v43, v150, v38
    v_dot2c_f32_bf16 v40, v139, v39
    v_dot2c_f32_bf16 v41, v143, v39
    v_dot2c_f32_bf16 v42, v147, v39
    v_dot2c_f32_bf16 v43, v151, v39
    v_add_f32_dpp v40, v40, v40 row_ror:8 row_mask:0xf bank_mask:0x3
    v_add_f32_dpp v41, v41, v41 row_ror:8 row_mask:0xf bank_mask:0x3
    s_nop 0
    v_add_f32_dpp v40, v42, v42 row_ror:8 row_mask:0xf bank_mask:0xc
    v_add_f32_dpp v41, v43, v43 row_ror:8 row_mask:0xf bank_mask:0xc
    s_nop 0
    v_add_f32_dpp v48, v40, v40 row_shl:4 row_mask:0xf bank_mask:0x5
    s_nop 1
    v_add_f32_dpp v48, v41, v41 row_shr:4 row_mask:0xf bank_mask:0xa
    s_nop 1
    v_add_f32_dpp v48, v48, v48 quad_perm:[1,0,3,2] row_mask:0xf bank_mask:0xf
    s_nop 1
    v_add_f32_dpp v48, v48, v48 quad_perm:[2,3,0,1] row_mask:0xf bank_mask:0xf
    v_cvt_pk_bf16_f32 v48, v48, v48
    v_and_b32 v48, 0xffff0000, v48
    v_mul_f32 v48, 0x3db504f3, v48
    v_cvt_pk_bf16_f32 v48, v48, v48
    v_and_b32 v48, 0xffff0000, v48
    v_max_f32 v8, v8, v48
    s_waitcnt vmcnt(16)
    s_mov_b32 s10, 151552
    buffer_load_dwordx4 v[220:223], v0, s[52:55], s10 offen nt
    s_waitcnt vmcnt(16)
    s_mov_b32 s10, 155648
    buffer_load_dwordx4 v[224:227], v0, s[52:55], s10 offen nt
    s_waitcnt vmcnt(15)
    v_dot2_f32_bf16 v40, v152, v36, 0
    v_dot2_f32_bf16 v41, v156, v36, 0
    v_dot2_f32_bf16 v42, v160, v36, 0
    v_dot2_f32_bf16 v43, v164, v36, 0
    v_dot2c_f32_bf16 v40, v153, v37
    v_dot2c_f32_bf16 v41, v157, v37
    v_dot2c_f32_bf16 v42, v161, v37
    v_dot2c_f32_bf16 v43, v165, v37
    v_dot2c_f32_bf16 v40, v154, v38
    v_dot2c_f32_bf16 v41, v158, v38
    v_dot2c_f32_bf16 v42, v162, v38
    v_dot2c_f32_bf16 v43, v166, v38
    v_dot2c_f32_bf16 v40, v155, v39
    v_dot2c_f32_bf16 v41, v159, v39
    v_dot2c_f32_bf16 v42, v163, v39
    v_dot2c_f32_bf16 v43, v167, v39
    v_add_f32_dpp v40, v40, v40 row_ror:8 row_mask:0xf bank_mask:0x3
    v_add_f32_dpp v41, v41, v41 row_ror:8 row_mask:0xf bank_mask:0x3
    s_nop 0
    v_add_f32_dpp v40, v42, v42 row_ror:8 row_mask:0xf bank_mask:0xc
    v_add_f32_dpp v41, v43, v43 row_ror:8 row_mask:0xf bank_mask:0xc
    s_nop 0
    v_add_f32_dpp v49, v40, v40 row_shl:4 row_mask:0xf bank_mask:0x5
    s_nop 1
    v_add_f32_dpp v49, v41, v41 row_shr:4 row_mask:0xf bank_mask:0xa
    s_nop 1
    v_add_f32_dpp v49, v49, v49 quad_perm:[1,0,3,2] row_mask:0xf bank_mask:0xf
    s_nop 1
    v_add_f32_dpp v49, v49, v49 quad_perm:[2,3,0,1] row_mask:0xf bank_mask:0xf
    v_cvt_pk_bf16_f32 v49, v49, v49
    v_and_b32 v49, 0xffff0000, v49
    v_mul_f32 v49, 0x3db504f3, v49
    v_cvt_pk_bf16_f32 v49, v49, v49
    v_and_b32 v49, 0xffff0000, v49
    v_max_f32 v8, v8, v49
    s_mov_b32 s10, 159744
    buffer_load_dwordx4 v[228:231], v0, s[52:55], s10 offen nt
    s_mov_b32 s10, 163840
    buffer_load_dwordx4 v[232:235], v0, s[52:55], s10 offen nt
    s_waitcnt vmcnt(13)
    v_dot2_f32_bf16 v40, v168, v36, 0
    v_dot2_f32_bf16 v41, v172, v36, 0
    v_dot2_f32_bf16 v42, v176, v36, 0
    v_dot2_f32_bf16 v43, v180, v36, 0
    v_dot2c_f32_bf16 v40, v169, v37
    v_dot2c_f32_bf16 v41, v173, v37
    v_dot2c_f32_bf16 v42, v177, v37
    v_dot2c_f32_bf16 v43, v181, v37
    v_dot2c_f32_bf16 v40, v170, v38
    v_dot2c_f32_bf16 v41, v174, v38
    v_dot2c_f32_bf16 v42, v178, v38
    v_dot2c_f32_bf16 v43, v182, v38
    v_dot2c_f32_bf16 v40, v171, v39
    v_dot2c_f32_bf16 v41, v175, v39
    v_dot2c_f32_bf16 v42, v179, v39
    v_dot2c_f32_bf16 v43, v183, v39
    v_add_f32_dpp v40, v40, v40 row_ror:8 row_mask:0xf bank_mask:0x3
    v_add_f32_dpp v41, v41, v41 row_ror:8 row_mask:0xf bank_mask:0x3
    s_nop 0
    v_add_f32_dpp v40, v42, v42 row_ror:8 row_mask:0xf bank_mask:0xc
    v_add_f32_dpp v41, v43, v43 row_ror:8 row_mask:0xf bank_mask:0xc
    s_nop 0
    v_add_f32_dpp v50, v40, v40 row_shl:4 row_mask:0xf bank_mask:0x5
    s_nop 1
    v_add_f32_dpp v50, v41, v41 row_shr:4 row_mask:0xf bank_mask:0xa
    s_nop 1
    v_add_f32_dpp v50, v50, v50 quad_perm:[1,0,3,2] row_mask:0xf bank_mask:0xf
    s_nop 1
    v_add_f32_dpp v50, v50, v50 quad_perm:[2,3,0,1] row_mask:0xf bank_mask:0xf
    v_cvt_pk_bf16_f32 v50, v50, v50
    v_and_b32 v50, 0xffff0000, v50
    v_mul_f32 v50, 0x3db504f3, v50
    v_cvt_pk_bf16_f32 v50, v50, v50
    v_and_b32 v50, 0xffff0000, v50
    v_max_f32 v8, v8, v50
    s_mov_b32 s10, 167936
    buffer_load_dwordx4 v[236:239], v0, s[52:55], s10 offen nt
    s_mov_b32 s10, 172032
    buffer_load_dwordx4 v[240:243], v0, s[52:55], s10 offen nt
    s_mov_b32 s10, 0
    buffer_load_dwordx4 a[0:3], v0, s[4:7], s10 offen nt
    s_mov_b32 s10, 4096
    buffer_load_dwordx4 a[4:7], v0, s[4:7], s10 offen nt
    s_mov_b32 s10, 8192
    buffer_load_dwordx4 a[8:11], v0, s[4:7], s10 offen nt
    s_waitcnt vmcnt(14)
    v_dot2_f32_bf16 v40, v184, v36, 0
    v_dot2_f32_bf16 v41, v188, v36, 0
    v_dot2_f32_bf16 v42, v192, v36, 0
    v_dot2_f32_bf16 v43, v196, v36, 0
    v_dot2c_f32_bf16 v40, v185, v37
    v_dot2c_f32_bf16 v41, v189, v37
    v_dot2c_f32_bf16 v42, v193, v37
    v_dot2c_f32_bf16 v43, v197, v37
    v_dot2c_f32_bf16 v40, v186, v38
    v_dot2c_f32_bf16 v41, v190, v38
    v_dot2c_f32_bf16 v42, v194, v38
    v_dot2c_f32_bf16 v43, v198, v38
    v_dot2c_f32_bf16 v40, v187, v39
    v_dot2c_f32_bf16 v41, v191, v39
    v_dot2c_f32_bf16 v42, v195, v39
    v_dot2c_f32_bf16 v43, v199, v39
    v_add_f32_dpp v40, v40, v40 row_ror:8 row_mask:0xf bank_mask:0x3
    v_add_f32_dpp v41, v41, v41 row_ror:8 row_mask:0xf bank_mask:0x3
    s_nop 0
    v_add_f32_dpp v40, v42, v42 row_ror:8 row_mask:0xf bank_mask:0xc
    v_add_f32_dpp v41, v43, v43 row_ror:8 row_mask:0xf bank_mask:0xc
    s_nop 0
    v_add_f32_dpp v51, v40, v40 row_shl:4 row_mask:0xf bank_mask:0x5
    s_nop 1
    v_add_f32_dpp v51, v41, v41 row_shr:4 row_mask:0xf bank_mask:0xa
    s_nop 1
    v_add_f32_dpp v51, v51, v51 quad_perm:[1,0,3,2] row_mask:0xf bank_mask:0xf
    s_nop 1
    v_add_f32_dpp v51, v51, v51 quad_perm:[2,3,0,1] row_mask:0xf bank_mask:0xf
    v_cvt_pk_bf16_f32 v51, v51, v51
    v_and_b32 v51, 0xffff0000, v51
    v_mul_f32 v51, 0x3db504f3, v51
    v_cvt_pk_bf16_f32 v51, v51, v51
    v_and_b32 v51, 0xffff0000, v51
    v_max_f32 v8, v8, v51
    s_mov_b32 s10, 12288
    buffer_load_dwordx4 a[12:15], v0, s[4:7], s10 offen nt
    s_mov_b32 s10, 16384
    buffer_load_dwordx4 a[16:19], v0, s[4:7], s10 offen nt
    s_mov_b32 s10, 20480
    buffer_load_dwordx4 a[20:23], v0, s[4:7], s10 offen nt
    s_mov_b32 s10, 24576
    buffer_load_dwordx4 a[24:27], v0, s[4:7], s10 offen nt
    s_waitcnt vmcnt(14)
    v_dot2_f32_bf16 v40, v200, v36, 0
    v_dot2_f32_bf16 v41, v204, v36, 0
    v_dot2_f32_bf16 v42, v208, v36, 0
    v_dot2_f32_bf16 v43, v212, v36, 0
    v_dot2c_f32_bf16 v40, v201, v37
    v_dot2c_f32_bf16 v41, v205, v37
    v_dot2c_f32_bf16 v42, v209, v37
    v_dot2c_f32_bf16 v43, v213, v37
    v_dot2c_f32_bf16 v40, v202, v38
    v_dot2c_f32_bf16 v41, v206, v38
    v_dot2c_f32_bf16 v42, v210, v38
    v_dot2c_f32_bf16 v43, v214, v38
    v_dot2c_f32_bf16 v40, v203, v39
    v_dot2c_f32_bf16 v41, v207, v39
    v_dot2c_f32_bf16 v42, v211, v39
    v_dot2c_f32_bf16 v43, v215, v39
    v_add_f32_dpp v40, v40, v40 row_ror:8 row_mask:0xf bank_mask:0x3
    v_add_f32_dpp v41, v41, v41 row_ror:8 row_mask:0xf bank_mask:0x3
    s_nop 0
    v_add_f32_dpp v40, v42, v42 row_ror:8 row_mask:0xf bank_mask:0xc
    v_add_f32_dpp v41, v43, v43 row_ror:8 row_mask:0xf bank_mask:0xc
    s_nop 0
    v_add_f32_dpp v52, v40, v40 row_shl:4 row_mask:0xf bank_mask:0x5
    s_nop 1
    v_add_f32_dpp v52, v41, v41 row_shr:4 row_mask:0xf bank_mask:0xa
    s_nop 1
    v_add_f32_dpp v52, v52, v52 quad_perm:[1,0,3,2] row_mask:0xf bank_mask:0xf
    s_nop 1
    v_add_f32_dpp v52, v52, v52 quad_perm:[2,3,0,1] row_mask:0xf bank_mask:0xf
    v_cvt_pk_bf16_f32 v52, v52, v52
    v_and_b32 v52, 0xffff0000, v52
    v_mul_f32 v52, 0x3db504f3, v52
    v_cvt_pk_bf16_f32 v52, v52, v52
    v_and_b32 v52, 0xffff0000, v52
    v_max_f32 v8, v8, v52
    s_mov_b32 s10, 28672
    buffer_load_dwordx4 a[28:31], v0, s[4:7], s10 offen nt
    s_mov_b32 s10, 32768
    buffer_load_dwordx4 a[32:35], v0, s[4:7], s10 offen nt
    s_mov_b32 s10, 36864
    buffer_load_dwordx4 a[36:39], v0, s[4:7], s10 offen nt
    s_mov_b32 s10, 40960
    buffer_load_dwordx4 a[40:43], v0, s[4:7], s10 offen nt
    s_waitcnt vmcnt(14)
    v_dot2_f32_bf16 v40, v216, v36, 0
    v_dot2_f32_bf16 v41, v220, v36, 0
    v_dot2_f32_bf16 v42, v224, v36, 0
    v_dot2_f32_bf16 v43, v228, v36, 0
    v_dot2c_f32_bf16 v40, v217, v37
    v_dot2c_f32_bf16 v41, v221, v37
    v_dot2c_f32_bf16 v42, v225, v37
    v_dot2c_f32_bf16 v43, v229, v37
    v_dot2c_f32_bf16 v40, v218, v38
    v_dot2c_f32_bf16 v41, v222, v38
    v_dot2c_f32_bf16 v42, v226, v38
    v_dot2c_f32_bf16 v43, v230, v38
    v_dot2c_f32_bf16 v40, v219, v39
    v_dot2c_f32_bf16 v41, v223, v39
    v_dot2c_f32_bf16 v42, v227, v39
    v_dot2c_f32_bf16 v43, v231, v39
    v_add_f32_dpp v40, v40, v40 row_ror:8 row_mask:0xf bank_mask:0x3
    v_add_f32_dpp v41, v41, v41 row_ror:8 row_mask:0xf bank_mask:0x3
    s_nop 0
    v_add_f32_dpp v40, v42, v42 row_ror:8 row_mask:0xf bank_mask:0xc
    v_add_f32_dpp v41, v43, v43 row_ror:8 row_mask:0xf bank_mask:0xc
    s_nop 0
    v_add_f32_dpp v53, v40, v40 row_shl:4 row_mask:0xf bank_mask:0x5
    s_nop 1
    v_add_f32_dpp v53, v41, v41 row_shr:4 row_mask:0xf bank_mask:0xa
    s_nop 1
    v_add_f32_dpp v53, v53, v53 quad_perm:[1,0,3,2] row_mask:0xf bank_mask:0xf
    s_nop 1
    v_add_f32_dpp v53, v53, v53 quad_perm:[2,3,0,1] row_mask:0xf bank_mask:0xf
    v_cvt_pk_bf16_f32 v53, v53, v53
    v_and_b32 v53, 0xffff0000, v53
    v_mul_f32 v53, 0x3db504f3, v53
    v_cvt_pk_bf16_f32 v53, v53, v53
    v_and_b32 v53, 0xffff0000, v53
    v_max_f32 v8, v8, v53
    s_mov_b32 s10, 45056
    buffer_load_dwordx4 a[44:47], v0, s[4:7], s10 offen nt
    s_mov_b32 s10, 49152
    buffer_load_dwordx4 a[48:51], v0, s[4:7], s10 offen nt
    s_mov_b32 s10, 53248
    buffer_load_dwordx4 a[52:55], v0, s[4:7], s10 offen nt
    s_waitcnt vmcnt(14)
    v_mov_b32 v43, 0xff800000
    v_dot2_f32_bf16 v40, v232, v36, 0
    v_dot2_f32_bf16 v41, v236, v36, 0
    v_dot2_f32_bf16 v42, v240, v36, 0
    s_nop 0
    v_dot2c_f32_bf16 v40, v233, v37
    v_dot2c_f32_bf16 v41, v237, v37
    v_dot2c_f32_bf16 v42, v241, v37
    v_dot2c_f32_bf16 v40, v234, v38
    v_dot2c_f32_bf16 v41, v238, v38
    v_dot2c_f32_bf16 v42, v242, v38
    v_dot2c_f32_bf16 v40, v235, v39
    v_dot2c_f32_bf16 v41, v239, v39
    v_dot2c_f32_bf16 v42, v243, v39
    s_nop 0
    v_add_f32_dpp v40, v40, v40 row_ror:8 row_mask:0xf bank_mask:0x3
    v_add_f32_dpp v41, v41, v41 row_ror:8 row_mask:0xf bank_mask:0x3
    s_nop 0
    v_add_f32_dpp v40, v42, v42 row_ror:8 row_mask:0xf bank_mask:0xc
    v_add_f32_dpp v41, v43, v43 row_ror:8 row_mask:0xf bank_mask:0xc
    s_nop 0
    v_add_f32_dpp v54, v40, v40 row_shl:4 row_mask:0xf bank_mask:0x5
    s_nop 1
    v_add_f32_dpp v54, v41, v41 row_shr:4 row_mask:0xf bank_mask:0xa
    s_nop 1
    v_add_f32_dpp v54, v54, v54 quad_perm:[1,0,3,2] row_mask:0xf bank_mask:0xf
    s_nop 1
    v_add_f32_dpp v54, v54, v54 quad_perm:[2,3,0,1] row_mask:0xf bank_mask:0xf
    v_cvt_pk_bf16_f32 v54, v54, v54
    v_and_b32 v54, 0xffff0000, v54
    v_mul_f32 v54, 0x3db504f3, v54
    v_cvt_pk_bf16_f32 v54, v54, v54
    v_and_b32 v54, 0xffff0000, v54
    v_max_f32 v8, v8, v54
    s_nop 1
    v_max_f32_dpp v8, v8, v8 row_ror:4 row_mask:0xf bank_mask:0xf
    s_nop 1
    v_max_f32_dpp v8, v8, v8 row_ror:8 row_mask:0xf bank_mask:0xf
    v_mov_b32 v7, v8
    s_nop 1
    v_permlane16_swap_b32 v7, v8
    v_max_f32 v8, v8, v7
    v_mov_b32 v7, v8
    s_nop 1
    v_permlane32_swap_b32 v7, v8
    v_max_f32 v8, v8, v7
    v_mul_f32 v8, s67, v8
    v_fma_f32 v44, v44, s67, -v8
    v_fma_f32 v45, v45, s67, -v8
    v_fma_f32 v46, v46, s67, -v8
    v_fma_f32 v47, v47, s67, -v8
    v_fma_f32 v48, v48, s67, -v8
    v_fma_f32 v49, v49, s67, -v8
    v_fma_f32 v50, v50, s67, -v8
    v_fma_f32 v51, v51, s67, -v8
    v_fma_f32 v52, v52, s67, -v8
    v_fma_f32 v53, v53, s67, -v8
    v_fma_f32 v54, v54, s67, -v8
    v_exp_f32 v44, v44
    v_exp_f32 v45, v45
    v_exp_f32 v46, v46
    v_exp_f32 v47, v47
    v_exp_f32 v48, v48
    v_exp_f32 v49, v49
    v_exp_f32 v50, v50
    v_exp_f32 v51, v51
    v_exp_f32 v52, v52
    v_exp_f32 v53, v53
    v_exp_f32 v54, v54
    v_add_f32 v5, v44, v45
    v_add_f32 v5, v5, v46
    v_add_f32 v5, v5, v47
    v_add_f32 v5, v5, v48
    v_add_f32 v5, v5, v49
    v_add_f32 v5, v5, v50
    v_add_f32 v5, v5, v51
    v_add_f32 v5, v5, v52
    v_add_f32 v5, v5, v53
    v_add_f32 v5, v5, v54
    v_cvt_pk_bf16_f32 v44, v44, v44
    v_cvt_pk_bf16_f32 v45, v45, v45
    v_cvt_pk_bf16_f32 v46, v46, v46
    v_cvt_pk_bf16_f32 v47, v47, v47
    v_cvt_pk_bf16_f32 v48, v48, v48
    v_cvt_pk_bf16_f32 v49, v49, v49
    v_cvt_pk_bf16_f32 v50, v50, v50
    v_cvt_pk_bf16_f32 v51, v51, v51
    v_cvt_pk_bf16_f32 v52, v52, v52
    v_cvt_pk_bf16_f32 v53, v53, v53
    v_cvt_pk_bf16_f32 v54, v54, v54
    v_add_f32_dpp v5, v5, v5 row_ror:4 row_mask:0xf bank_mask:0xf
    s_nop 1
    v_add_f32_dpp v5, v5, v5 row_ror:8 row_mask:0xf bank_mask:0xf
    v_mov_b32 v7, v5
    s_nop 1
    v_permlane16_swap_b32 v7, v5
    v_add_f32 v5, v5, v7
    v_mov_b32 v7, v5
    s_nop 1
    v_permlane32_swap_b32 v7, v5
    v_add_f32 v5, v5, v7
    s_lshl_b32 s3, s56, 2
    s_add_u32 s3, s3, 13440
    v_mov_b32 v7, s3
    ds_write2_b32 v7, v8, v5 offset0:0 offset1:4
    s_lshl_b32 s62, s57, 1
    s_add_u32 s62, s62, s58
    s_mul_i32 s62, s62, 3
    s_add_u32 s62, s62, s59
    s_lshl_b32 s62, s62, 10
    s_add_u32 s68, s62, 524288
    v_mov_b32 v37, 0
    v_mov_b32 v4, 0
    v_mov_b32 v5, 1
    s_mov_b64 exec, 1
    ds_add_rtn_u32 v5, v4, v5 offset:13324
    s_mov_b64 exec, -1
    s_waitcnt lgkmcnt(0)
    v_readfirstlane_b32 s3, v5
    s_cmp_lg_u32 s3, 3
    s_cbranch_scc1 L_nostat_12
    ds_read_b128 v[56:59], v37 offset:13440
    ds_read_b128 v[60:63], v37 offset:13456
    v_mov_b32 v6, s60
    v_mov_b32 v7, s60
    s_waitcnt lgkmcnt(0)
    v_max3_f32 v4, v56, v57, v58
    v_max_f32 v4, v4, v59
    v_sub_f32 v56, v56, v4
    v_sub_f32 v57, v57, v4
    v_sub_f32 v58, v58, v4
    v_sub_f32 v59, v59, v4
    v_exp_f32 v56, v56
    v_exp_f32 v57, v57
    v_exp_f32 v58, v58
    v_exp_f32 v59, v59
    v_mul_f32 v5, v60, v56
    v_fmac_f32 v5, v61, v57
    v_fmac_f32 v5, v62, v58
    v_fmac_f32 v5, v63, v59
    ds_write_b128 v37, v[56:59] offset:13472
    s_mov_b64 exec, 1
    s_cmp_eq_u32 s0, 0
    s_cbranch_scc1 L_far_13
    buffer_store_dwordx4 v[4:7], v37, s[48:51], s68 offen offset:512
    s_branch L_join_14
L_far_13:
    buffer_store_dwordx4 v[4:7], v37, s[48:51], s68 offen offset:512 sc1
L_join_14:
    s_nop 1
    s_mov_b64 exec, -1
L_nostat_12:
    v_and_b32 v4, 1, v3
    v_lshlrev_b32 v5, 5, v2
    v_lshl_add_u32 v5, v4, 4, v5
    s_lshl_b32 s3, s56, 9
    v_add_u32 v5, s3, v5
    v_mov_b32 v36, v5
    v_mov_b32 v8, 1
    s_mov_b32 s10, 57344
    buffer_load_dwordx4 a[56:59], v0, s[4:7], s10 offen nt
    v_and_b32_dpp v72, v44, v10 row_newbcast:0 row_mask:0xf bank_mask:0xf
    v_and_b32_dpp v73, v44, v11 row_newbcast:0 row_mask:0xf bank_mask:0xf
    v_and_b32_dpp v74, v44, v12 row_newbcast:0 row_mask:0xf bank_mask:0xf
    v_and_b32_dpp v75, v44, v13 row_newbcast:0 row_mask:0xf bank_mask:0xf
    v_and_b32_dpp v76, v44, v10 row_newbcast:4 row_mask:0xf bank_mask:0xf
    v_and_b32_dpp v77, v44, v11 row_newbcast:4 row_mask:0xf bank_mask:0xf
    v_and_b32_dpp v78, v44, v12 row_newbcast:4 row_mask:0xf bank_mask:0xf
    v_and_b32_dpp v79, v44, v13 row_newbcast:4 row_mask:0xf bank_mask:0xf
    s_mov_b32 s10, 61440
    buffer_load_dwordx4 a[60:63], v0, s[4:7], s10 offen nt
    v_and_b32_dpp v80, v44, v10 row_newbcast:8 row_mask:0xf bank_mask:0xf
    v_and_b32_dpp v81, v44, v11 row_newbcast:8 row_mask:0xf bank_mask:0xf
    v_and_b32_dpp v82, v44, v12 row_newbcast:8 row_mask:0xf bank_mask:0xf
    v_and_b32_dpp v83, v44, v13 row_newbcast:8 row_mask:0xf bank_mask:0xf
    v_and_b32_dpp v84, v44, v10 row_newbcast:12 row_mask:0xf bank_mask:0xf
    v_and_b32_dpp v85, v44, v11 row_newbcast:12 row_mask:0xf bank_mask:0xf
    v_and_b32_dpp v86, v44, v12 row_newbcast:12 row_mask:0xf bank_mask:0xf
    v_and_b32_dpp v87, v44, v13 row_newbcast:12 row_mask:0xf bank_mask:0xf
    s_mov_b32 s10, 65536
    buffer_load_dwordx4 a[64:67], v0, s[4:7], s10 offen nt
    v_and_b32_dpp v88, v45, v10 row_newbcast:0 row_mask:0xf bank_mask:0xf
    v_and_b32_dpp v89, v45, v11 row_newbcast:0 row_mask:0xf bank_mask:0xf
    v_and_b32_dpp v90, v45, v12 row_newbcast:0 row_mask:0xf bank_mask:0xf
    v_and_b32_dpp v91, v45, v13 row_newbcast:0 row_mask:0xf bank_mask:0xf
    v_and_b32_dpp v92, v45, v10 row_newbcast:4 row_mask:0xf bank_mask:0xf
    v_and_b32_dpp v93, v45, v11 row_newbcast:4 row_mask:0xf bank_mask:0xf
    v_and_b32_dpp v94, v45, v12 row_newbcast:4 row_mask:0xf bank_mask:0xf
    v_and_b32_dpp v95, v45, v13 row_newbcast:4 row_mask:0xf bank_mask:0xf
    s_mov_b32 s10, 69632
    buffer_load_dwordx4 a[68:71], v0, s[4:7], s10 offen nt
    v_and_b32_dpp v96, v45, v10 row_newbcast:8 row_mask:0xf bank_mask:0xf
    v_and_b32_dpp v97, v45, v11 row_newbcast:8 row_mask:0xf bank_mask:0xf
    v_and_b32_dpp v98, v45, v12 row_newbcast:8 row_mask:0xf bank_mask:0xf
    v_and_b32_dpp v99, v45, v13 row_newbcast:8 row_mask:0xf bank_mask:0xf
    v_and_b32_dpp v100, v45, v10 row_newbcast:12 row_mask:0xf bank_mask:0xf
    v_and_b32_dpp v101, v45, v11 row_newbcast:12 row_mask:0xf bank_mask:0xf
    v_and_b32_dpp v102, v45, v12 row_newbcast:12 row_mask:0xf bank_mask:0xf
    v_and_b32_dpp v103, v45, v13 row_newbcast:12 row_mask:0xf bank_mask:0xf
    s_mov_b32 s10, 73728
    buffer_load_dwordx4 a[72:75], v0, s[4:7], s10 offen nt
    v_and_b32_dpp v104, v46, v10 row_newbcast:0 row_mask:0xf bank_mask:0xf
    v_and_b32_dpp v105, v46, v11 row_newbcast:0 row_mask:0xf bank_mask:0xf
    v_and_b32_dpp v106, v46, v12 row_newbcast:0 row_mask:0xf bank_mask:0xf
    v_and_b32_dpp v107, v46, v13 row_newbcast:0 row_mask:0xf bank_mask:0xf
    v_and_b32_dpp v108, v46, v10 row_newbcast:4 row_mask:0xf bank_mask:0xf
    v_and_b32_dpp v109, v46, v11 row_newbcast:4 row_mask:0xf bank_mask:0xf
    v_and_b32_dpp v110, v46, v12 row_newbcast:4 row_mask:0xf bank_mask:0xf
    v_and_b32_dpp v111, v46, v13 row_newbcast:4 row_mask:0xf bank_mask:0xf
    s_mov_b32 s10, 77824
    buffer_load_dwordx4 a[76:79], v0, s[4:7], s10 offen nt
    v_and_b32_dpp v112, v46, v10 row_newbcast:8 row_mask:0xf bank_mask:0xf
    v_and_b32_dpp v113, v46, v11 row_newbcast:8 row_mask:0xf bank_mask:0xf
    v_and_b32_dpp v114, v46, v12 row_newbcast:8 row_mask:0xf bank_mask:0xf
    v_and_b32_dpp v115, v46, v13 row_newbcast:8 row_mask:0xf bank_mask:0xf
    v_and_b32_dpp v116, v46, v10 row_newbcast:12 row_mask:0xf bank_mask:0xf
    v_and_b32_dpp v117, v46, v11 row_newbcast:12 row_mask:0xf bank_mask:0xf
    v_and_b32_dpp v118, v46, v12 row_newbcast:12 row_mask:0xf bank_mask:0xf
    v_and_b32_dpp v119, v46, v13 row_newbcast:12 row_mask:0xf bank_mask:0xf
    s_mov_b32 s10, 81920
    buffer_load_dwordx4 a[80:83], v0, s[4:7], s10 offen nt
    v_and_b32_dpp v120, v47, v10 row_newbcast:0 row_mask:0xf bank_mask:0xf
    v_and_b32_dpp v121, v47, v11 row_newbcast:0 row_mask:0xf bank_mask:0xf
    v_and_b32_dpp v122, v47, v12 row_newbcast:0 row_mask:0xf bank_mask:0xf
    v_and_b32_dpp v123, v47, v13 row_newbcast:0 row_mask:0xf bank_mask:0xf
    v_and_b32_dpp v124, v47, v10 row_newbcast:4 row_mask:0xf bank_mask:0xf
    v_and_b32_dpp v125, v47, v11 row_newbcast:4 row_mask:0xf bank_mask:0xf
    v_and_b32_dpp v126, v47, v12 row_newbcast:4 row_mask:0xf bank_mask:0xf
    v_and_b32_dpp v127, v47, v13 row_newbcast:4 row_mask:0xf bank_mask:0xf
    s_mov_b32 s10, 86016
    buffer_load_dwordx4 a[84:87], v0, s[4:7], s10 offen nt
    v_and_b32_dpp v128, v47, v10 row_newbcast:8 row_mask:0xf bank_mask:0xf
    v_and_b32_dpp v129, v47, v11 row_newbcast:8 row_mask:0xf bank_mask:0xf
    v_and_b32_dpp v130, v47, v12 row_newbcast:8 row_mask:0xf bank_mask:0xf
    v_and_b32_dpp v131, v47, v13 row_newbcast:8 row_mask:0xf bank_mask:0xf
    v_and_b32_dpp v132, v47, v10 row_newbcast:12 row_mask:0xf bank_mask:0xf
    v_and_b32_dpp v133, v47, v11 row_newbcast:12 row_mask:0xf bank_mask:0xf
    v_and_b32_dpp v134, v47, v12 row_newbcast:12 row_mask:0xf bank_mask:0xf
    v_and_b32_dpp v135, v47, v13 row_newbcast:12 row_mask:0xf bank_mask:0xf
    s_mov_b32 s10, 90112
    buffer_load_dwordx4 a[88:91], v0, s[4:7], s10 offen nt
    v_and_b32_dpp v136, v48, v10 row_newbcast:0 row_mask:0xf bank_mask:0xf
    v_and_b32_dpp v137, v48, v11 row_newbcast:0 row_mask:0xf bank_mask:0xf
    v_and_b32_dpp v138, v48, v12 row_newbcast:0 row_mask:0xf bank_mask:0xf
    v_and_b32_dpp v139, v48, v13 row_newbcast:0 row_mask:0xf bank_mask:0xf
    v_and_b32_dpp v140, v48, v10 row_newbcast:4 row_mask:0xf bank_mask:0xf
    v_and_b32_dpp v141, v48, v11 row_newbcast:4 row_mask:0xf bank_mask:0xf
    v_and_b32_dpp v142, v48, v12 row_newbcast:4 row_mask:0xf bank_mask:0xf
    v_and_b32_dpp v143, v48, v13 row_newbcast:4 row_mask:0xf bank_mask:0xf
    s_mov_b32 s10, 94208
    buffer_load_dwordx4 a[92:95], v0, s[4:7], s10 offen nt
    v_and_b32_dpp v144, v48, v10 row_newbcast:8 row_mask:0xf bank_mask:0xf
    v_and_b32_dpp v145, v48, v11 row_newbcast:8 row_mask:0xf bank_mask:0xf
    v_and_b32_dpp v146, v48, v12 row_newbcast:8 row_mask:0xf bank_mask:0xf
    v_and_b32_dpp v147, v48, v13 row_newbcast:8 row_mask:0xf bank_mask:0xf
    v_and_b32_dpp v148, v48, v10 row_newbcast:12 row_mask:0xf bank_mask:0xf
    v_and_b32_dpp v149, v48, v11 row_newbcast:12 row_mask:0xf bank_mask:0xf
    v_and_b32_dpp v150, v48, v12 row_newbcast:12 row_mask:0xf bank_mask:0xf
    v_and_b32_dpp v151, v48, v13 row_newbcast:12 row_mask:0xf bank_mask:0xf
    s_mov_b32 s10, 98304
    buffer_load_dwordx4 a[96:99], v0, s[4:7], s10 offen nt
    v_and_b32_dpp v152, v49, v10 row_newbcast:0 row_mask:0xf bank_mask:0xf
    v_and_b32_dpp v153, v49, v11 row_newbcast:0 row_mask:0xf bank_mask:0xf
    v_and_b32_dpp v154, v49, v12 row_newbcast:0 row_mask:0xf bank_mask:0xf
    v_and_b32_dpp v155, v49, v13 row_newbcast:0 row_mask:0xf bank_mask:0xf
    v_and_b32_dpp v156, v49, v10 row_newbcast:4 row_mask:0xf bank_mask:0xf
    v_and_b32_dpp v157, v49, v11 row_newbcast:4 row_mask:0xf bank_mask:0xf
    v_and_b32_dpp v158, v49, v12 row_newbcast:4 row_mask:0xf bank_mask:0xf
    v_and_b32_dpp v159, v49, v13 row_newbcast:4 row_mask:0xf bank_mask:0xf
    s_mov_b32 s10, 102400
    buffer_load_dwordx4 a[100:103], v0, s[4:7], s10 offen nt
    v_and_b32_dpp v160, v49, v10 row_newbcast:8 row_mask:0xf bank_mask:0xf
    v_and_b32_dpp v161, v49, v11 row_newbcast:8 row_mask:0xf bank_mask:0xf
    v_and_b32_dpp v162, v49, v12 row_newbcast:8 row_mask:0xf bank_mask:0xf
    v_and_b32_dpp v163, v49, v13 row_newbcast:8 row_mask:0xf bank_mask:0xf
    v_and_b32_dpp v164, v49, v10 row_newbcast:12 row_mask:0xf bank_mask:0xf
    v_and_b32_dpp v165, v49, v11 row_newbcast:12 row_mask:0xf bank_mask:0xf
    v_and_b32_dpp v166, v49, v12 row_newbcast:12 row_mask:0xf bank_mask:0xf
    v_and_b32_dpp v167, v49, v13 row_newbcast:12 row_mask:0xf bank_mask:0xf
    s_mov_b32 s10, 106496
    buffer_load_dwordx4 a[104:107], v0, s[4:7], s10 offen nt
    v_and_b32_dpp v168, v50, v10 row_newbcast:0 row_mask:0xf bank_mask:0xf
    v_and_b32_dpp v169, v50, v11 row_newbcast:0 row_mask:0xf bank_mask:0xf
    v_and_b32_dpp v170, v50, v12 row_newbcast:0 row_mask:0xf bank_mask:0xf
    v_and_b32_dpp v171, v50, v13 row_newbcast:0 row_mask:0xf bank_mask:0xf
    v_and_b32_dpp v172, v50, v10 row_newbcast:4 row_mask:0xf bank_mask:0xf
    v_and_b32_dpp v173, v50, v11 row_newbcast:4 row_mask:0xf bank_mask:0xf
    v_and_b32_dpp v174, v50, v12 row_newbcast:4 row_mask:0xf bank_mask:0xf
    v_and_b32_dpp v175, v50, v13 row_newbcast:4 row_mask:0xf bank_mask:0xf
    s_mov_b32 s10, 110592
    buffer_load_dwordx4 a[108:111], v0, s[4:7], s10 offen nt
    v_and_b32_dpp v176, v50, v10 row_newbcast:8 row_mask:0xf bank_mask:0xf
    v_and_b32_dpp v177, v50, v11 row_newbcast:8 row_mask:0xf bank_mask:0xf
    v_and_b32_dpp v178, v50, v12 row_newbcast:8 row_mask:0xf bank_mask:0xf
    v_and_b32_dpp v179, v50, v13 row_newbcast:8 row_mask:0xf bank_mask:0xf
    v_and_b32_dpp v180, v50, v10 row_newbcast:12 row_mask:0xf bank_mask:0xf
    v_and_b32_dpp v181, v50, v11 row_newbcast:12 row_mask:0xf bank_mask:0xf
    v_and_b32_dpp v182, v50, v12 row_newbcast:12 row_mask:0xf bank_mask:0xf
    v_and_b32_dpp v183, v50, v13 row_newbcast:12 row_mask:0xf bank_mask:0xf
    s_mov_b32 s10, 114688
    buffer_load_dwordx4 a[112:115], v0, s[4:7], s10 offen nt
    v_and_b32_dpp v184, v51, v10 row_newbcast:0 row_mask:0xf bank_mask:0xf
    v_and_b32_dpp v185, v51, v11 row_newbcast:0 row_mask:0xf bank_mask:0xf
    v_and_b32_dpp v186, v51, v12 row_newbcast:0 row_mask:0xf bank_mask:0xf
    v_and_b32_dpp v187, v51, v13 row_newbcast:0 row_mask:0xf bank_mask:0xf
    v_and_b32_dpp v188, v51, v10 row_newbcast:4 row_mask:0xf bank_mask:0xf
    v_and_b32_dpp v189, v51, v11 row_newbcast:4 row_mask:0xf bank_mask:0xf
    v_and_b32_dpp v190, v51, v12 row_newbcast:4 row_mask:0xf bank_mask:0xf
    v_and_b32_dpp v191, v51, v13 row_newbcast:4 row_mask:0xf bank_mask:0xf
    s_mov_b32 s10, 118784
    buffer_load_dwordx4 a[116:119], v0, s[4:7], s10 offen nt
    v_and_b32_dpp v192, v51, v10 row_newbcast:8 row_mask:0xf bank_mask:0xf
    v_and_b32_dpp v193, v51, v11 row_newbcast:8 row_mask:0xf bank_mask:0xf
    v_and_b32_dpp v194, v51, v12 row_newbcast:8 row_mask:0xf bank_mask:0xf
    v_and_b32_dpp v195, v51, v13 row_newbcast:8 row_mask:0xf bank_mask:0xf
    v_and_b32_dpp v196, v51, v10 row_newbcast:12 row_mask:0xf bank_mask:0xf
    v_and_b32_dpp v197, v51, v11 row_newbcast:12 row_mask:0xf bank_mask:0xf
    v_and_b32_dpp v198, v51, v12 row_newbcast:12 row_mask:0xf bank_mask:0xf
    v_and_b32_dpp v199, v51, v13 row_newbcast:12 row_mask:0xf bank_mask:0xf
    s_mov_b32 s10, 122880
    buffer_load_dwordx4 a[120:123], v0, s[4:7], s10 offen nt
    v_and_b32_dpp v200, v52, v10 row_newbcast:0 row_mask:0xf bank_mask:0xf
    v_and_b32_dpp v201, v52, v11 row_newbcast:0 row_mask:0xf bank_mask:0xf
    v_and_b32_dpp v202, v52, v12 row_newbcast:0 row_mask:0xf bank_mask:0xf
    v_and_b32_dpp v203, v52, v13 row_newbcast:0 row_mask:0xf bank_mask:0xf
    v_and_b32_dpp v204, v52, v10 row_newbcast:4 row_mask:0xf bank_mask:0xf
    v_and_b32_dpp v205, v52, v11 row_newbcast:4 row_mask:0xf bank_mask:0xf
    v_and_b32_dpp v206, v52, v12 row_newbcast:4 row_mask:0xf bank_mask:0xf
    v_and_b32_dpp v207, v52, v13 row_newbcast:4 row_mask:0xf bank_mask:0xf
    s_mov_b32 s10, 126976
    buffer_load_dwordx4 a[124:127], v0, s[4:7], s10 offen nt
    v_and_b32_dpp v208, v52, v10 row_newbcast:8 row_mask:0xf bank_mask:0xf
    v_and_b32_dpp v209, v52, v11 row_newbcast:8 row_mask:0xf bank_mask:0xf
    v_and_b32_dpp v210, v52, v12 row_newbcast:8 row_mask:0xf bank_mask:0xf
    v_and_b32_dpp v211, v52, v13 row_newbcast:8 row_mask:0xf bank_mask:0xf
    v_and_b32_dpp v212, v52, v10 row_newbcast:12 row_mask:0xf bank_mask:0xf
    v_and_b32_dpp v213, v52, v11 row_newbcast:12 row_mask:0xf bank_mask:0xf
    v_and_b32_dpp v214, v52, v12 row_newbcast:12 row_mask:0xf bank_mask:0xf
    v_and_b32_dpp v215, v52, v13 row_newbcast:12 row_mask:0xf bank_mask:0xf
    s_mov_b32 s10, 131072
    buffer_load_dwordx4 a[128:131], v0, s[4:7], s10 offen nt
    v_and_b32_dpp v216, v53, v10 row_newbcast:0 row_mask:0xf bank_mask:0xf
    v_and_b32_dpp v217, v53, v11 row_newbcast:0 row_mask:0xf bank_mask:0xf
    v_and_b32_dpp v218, v53, v12 row_newbcast:0 row_mask:0xf bank_mask:0xf
    v_and_b32_dpp v219, v53, v13 row_newbcast:0 row_mask:0xf bank_mask:0xf
    v_and_b32_dpp v220, v53, v10 row_newbcast:4 row_mask:0xf bank_mask:0xf
    v_and_b32_dpp v221, v53, v11 row_newbcast:4 row_mask:0xf bank_mask:0xf
    v_and_b32_dpp v222, v53, v12 row_newbcast:4 row_mask:0xf bank_mask:0xf
    v_and_b32_dpp v223, v53, v13 row_newbcast:4 row_mask:0xf bank_mask:0xf
    s_mov_b32 s10, 135168
    buffer_load_dwordx4 a[132:135], v0, s[4:7], s10 offen nt
    v_and_b32_dpp v224, v53, v10 row_newbcast:8 row_mask:0xf bank_mask:0xf
    v_and_b32_dpp v225, v53, v11 row_newbcast:8 row_mask:0xf bank_mask:0xf
    v_and_b32_dpp v226, v53, v12 row_newbcast:8 row_mask:0xf bank_mask:0xf
    v_and_b32_dpp v227, v53, v13 row_newbcast:8 row_mask:0xf bank_mask:0xf
    v_and_b32_dpp v228, v53, v10 row_newbcast:12 row_mask:0xf bank_mask:0xf
    v_and_b32_dpp v229, v53, v11 row_newbcast:12 row_mask:0xf bank_mask:0xf
    v_and_b32_dpp v230, v53, v12 row_newbcast:12 row_mask:0xf bank_mask:0xf
    v_and_b32_dpp v231, v53, v13 row_newbcast:12 row_mask:0xf bank_mask:0xf
    s_mov_b32 s10, 139264
    buffer_load_dwordx4 a[136:139], v0, s[4:7], s10 offen nt
    v_and_b32_dpp v232, v54, v10 row_newbcast:0 row_mask:0xf bank_mask:0xf
    v_and_b32_dpp v233, v54, v11 row_newbcast:0 row_mask:0xf bank_mask:0xf
    v_and_b32_dpp v234, v54, v12 row_newbcast:0 row_mask:0xf bank_mask:0xf
    v_and_b32_dpp v235, v54, v13 row_newbcast:0 row_mask:0xf bank_mask:0xf
    v_and_b32_dpp v236, v54, v10 row_newbcast:4 row_mask:0xf bank_mask:0xf
    v_and_b32_dpp v237, v54, v11 row_newbcast:4 row_mask:0xf bank_mask:0xf
    v_and_b32_dpp v238, v54, v12 row_newbcast:4 row_mask:0xf bank_mask:0xf
    v_and_b32_dpp v239, v54, v13 row_newbcast:4 row_mask:0xf bank_mask:0xf
    s_mov_b32 s10, 143360
    buffer_load_dwordx4 a[140:143], v0, s[4:7], s10 offen nt
    v_and_b32_dpp v240, v54, v10 row_newbcast:8 row_mask:0xf bank_mask:0xf
    v_and_b32_dpp v241, v54, v11 row_newbcast:8 row_mask:0xf bank_mask:0xf
    v_and_b32_dpp v242, v54, v12 row_newbcast:8 row_mask:0xf bank_mask:0xf
    v_and_b32_dpp v243, v54, v13 row_newbcast:8 row_mask:0xf bank_mask:0xf
    s_mov_b32 s10, 147456
    buffer_load_dwordx4 a[144:147], v0, s[4:7], s10 offen nt
    s_mov_b32 s10, 151552
    buffer_load_dwordx4 a[148:151], v0, s[4:7], s10 offen nt
    s_mov_b32 s10, 155648
    buffer_load_dwordx4 a[152:155], v0, s[4:7], s10 offen nt
    s_mov_b32 s10, 159744
    buffer_load_dwordx4 a[156:159], v0, s[4:7], s10 offen nt
    s_mov_b32 s10, 163840
    buffer_load_dwordx4 a[160:163], v0, s[4:7], s10 offen nt
    s_mov_b32 s10, 167936
    buffer_load_dwordx4 a[164:167], v0, s[4:7], s10 offen nt
    s_mov_b32 s10, 172032
    buffer_load_dwordx4 a[168:171], v0, s[4:7], s10 offen nt
    s_waitcnt vmcnt(39)
    v_mfma_f32_16x16x32_bf16 v[32:35], v[72:75], a[0:3], 0
    v_mfma_f32_16x16x32_bf16 v[32:35], v[76:79], a[4:7], v[32:35]
    v_mfma_f32_16x16x32_bf16 v[32:35], v[80:83], a[8:11], v[32:35]
    v_mfma_f32_16x16x32_bf16 v[32:35], v[84:87], a[12:15], v[32:35]
    s_waitcnt vmcnt(35)
    v_mfma_f32_16x16x32_bf16 v[32:35], v[88:91], a[16:19], v[32:35]
    v_mfma_f32_16x16x32_bf16 v[32:35], v[92:95], a[20:23], v[32:35]
    v_mfma_f32_16x16x32_bf16 v[32:35], v[96:99], a[24:27], v[32:35]
    v_mfma_f32_16x16x32_bf16 v[32:35], v[100:103], a[28:31], v[32:35]
    s_waitcnt vmcnt(31)
    v_mfma_f32_16x16x32_bf16 v[32:35], v[104:107], a[32:35], v[32:35]
    v_mfma_f32_16x16x32_bf16 v[32:35], v[108:111], a[36:39], v[32:35]
    v_mfma_f32_16x16x32_bf16 v[32:35], v[112:115], a[40:43], v[32:35]
    v_mfma_f32_16x16x32_bf16 v[32:35], v[116:119], a[44:47], v[32:35]
    s_waitcnt vmcnt(27)
    v_mfma_f32_16x16x32_bf16 v[32:35], v[120:123], a[48:51], v[32:35]
    v_mfma_f32_16x16x32_bf16 v[32:35], v[124:127], a[52:55], v[32:35]
    v_mfma_f32_16x16x32_bf16 v[32:35], v[128:131], a[56:59], v[32:35]
    v_mfma_f32_16x16x32_bf16 v[32:35], v[132:135], a[60:63], v[32:35]
    s_waitcnt vmcnt(23)
    v_mfma_f32_16x16x32_bf16 v[32:35], v[136:139], a[64:67], v[32:35]
    v_mfma_f32_16x16x32_bf16 v[32:35], v[140:143], a[68:71], v[32:35]
    v_mfma_f32_16x16x32_bf16 v[32:35], v[144:147], a[72:75], v[32:35]
    v_mfma_f32_16x16x32_bf16 v[32:35], v[148:151], a[76:79], v[32:35]
    s_waitcnt vmcnt(19)
    v_mfma_f32_16x16x32_bf16 v[32:35], v[152:155], a[80:83], v[32:35]
    v_mfma_f32_16x16x32_bf16 v[32:35], v[156:159], a[84:87], v[32:35]
    v_mfma_f32_16x16x32_bf16 v[32:35], v[160:163], a[88:91], v[32:35]
    v_mfma_f32_16x16x32_bf16 v[32:35], v[164:167], a[92:95], v[32:35]
    s_waitcnt vmcnt(15)
    v_mfma_f32_16x16x32_bf16 v[32:35], v[168:171], a[96:99], v[32:35]
    v_mfma_f32_16x16x32_bf16 v[32:35], v[172:175], a[100:103], v[32:35]
    v_mfma_f32_16x16x32_bf16 v[32:35], v[176:179], a[104:107], v[32:35]
    v_mfma_f32_16x16x32_bf16 v[32:35], v[180:183], a[108:111], v[32:35]
    s_waitcnt vmcnt(11)
    v_mfma_f32_16x16x32_bf16 v[32:35], v[184:187], a[112:115], v[32:35]
    v_mfma_f32_16x16x32_bf16 v[32:35], v[188:191], a[116:119], v[32:35]
    v_mfma_f32_16x16x32_bf16 v[32:35], v[192:195], a[120:123], v[32:35]
    v_mfma_f32_16x16x32_bf16 v[32:35], v[196:199], a[124:127], v[32:35]
    s_waitcnt vmcnt(7)
    v_mfma_f32_16x16x32_bf16 v[32:35], v[200:203], a[128:131], v[32:35]
    v_mfma_f32_16x16x32_bf16 v[32:35], v[204:207], a[132:135], v[32:35]
    v_mfma_f32_16x16x32_bf16 v[32:35], v[208:211], a[136:139], v[32:35]
    v_mfma_f32_16x16x32_bf16 v[32:35], v[212:215], a[140:143], v[32:35]
    s_waitcnt vmcnt(6)
    v_mfma_f32_16x16x32_bf16 v[32:35], v[216:219], a[144:147], v[32:35]
    s_waitcnt vmcnt(5)
    v_mfma_f32_16x16x32_bf16 v[32:35], v[220:223], a[148:151], v[32:35]
    s_waitcnt vmcnt(4)
    v_mfma_f32_16x16x32_bf16 v[32:35], v[224:227], a[152:155], v[32:35]
    s_waitcnt vmcnt(3)
    v_mfma_f32_16x16x32_bf16 v[32:35], v[228:231], a[156:159], v[32:35]
    s_waitcnt vmcnt(2)
    v_mfma_f32_16x16x32_bf16 v[32:35], v[232:235], a[160:163], v[32:35]
    s_waitcnt vmcnt(1)
    v_mfma_f32_16x16x32_bf16 v[32:35], v[236:239], a[164:167], v[32:35]
    s_waitcnt vmcnt(0)
    v_mfma_f32_16x16x32_bf16 v[32:35], v[240:243], a[168:171], v[32:35]
    s_nop 7
    ds_write_b128 v36, v[32:35] offset:14336
    s_mov_b64 exec, 1
    ds_add_rtn_u32 v5, v37, v8 offset:13320
    s_mov_b64 exec, -1
    ds_read_b128 v[40:43], v37 offset:13472
    ds_read_b128 v[56:59], v22 offset:14336
    ds_read_b128 v[60:63], v22 offset:14848
    ds_read_b128 v[64:67], v22 offset:15360
    ds_read_b128 v[68:71], v22 offset:15872
    s_waitcnt lgkmcnt(5)
    v_readfirstlane_b32 s3, v5
    s_cmp_lg_u32 s3, 3
    s_cbranch_scc1 L_done_15
    s_mov_b32 exec_hi, 0
    s_waitcnt lgkmcnt(3)
    v_pk_mul_f32 v[32:33], v[56:57], v[40:41] op_sel:[0,0] op_sel_hi:[1,0]
    v_pk_mul_f32 v[34:35], v[58:59], v[40:41] op_sel:[0,0] op_sel_hi:[1,0]
    s_waitcnt lgkmcnt(2)
    v_pk_fma_f32 v[32:33], v[60:61], v[40:41], v[32:33] op_sel:[0,1,0] op_sel_hi:[1,1,1]
    v_pk_fma_f32 v[34:35], v[62:63], v[40:41], v[34:35] op_sel:[0,1,0] op_sel_hi:[1,1,1]
    s_waitcnt lgkmcnt(1)
    v_pk_fma_f32 v[32:33], v[64:65], v[42:43], v[32:33] op_sel:[0,0,0] op_sel_hi:[1,0,1]
    v_pk_fma_f32 v[34:35], v[66:67], v[42:43], v[34:35] op_sel:[0,0,0] op_sel_hi:[1,0,1]
    s_waitcnt lgkmcnt(0)
    v_pk_fma_f32 v[32:33], v[68:69], v[42:43], v[32:33] op_sel:[0,1,0] op_sel_hi:[1,1,1]
    v_pk_fma_f32 v[34:35], v[70:71], v[42:43], v[34:35] op_sel:[0,1,0] op_sel_hi:[1,1,1]
    v_add_u32 v32, 0x800, v32
    v_add_u32 v33, 0x800, v33
    v_add_u32 v34, 0x800, v34
    v_add_u32 v35, 0x800, v35
    v_bfi_b32 v32, s65, v9, v32
    v_bfi_b32 v33, s65, v9, v33
    v_bfi_b32 v34, s65, v9, v34
    v_bfi_b32 v35, s65, v9, v35
    s_cmp_eq_u32 s0, 0
    s_cbranch_scc1 L_far_16
    buffer_store_dwordx4 v[32:35], v22, s[48:51], s68 offen
    s_branch L_join_17
L_far_16:
    buffer_store_dwordx4 v[32:35], v22, s[48:51], s68 offen sc1
L_join_17:
    s_nop 1
    s_mov_b64 exec, -1
L_done_15:
    s_barrier
    s_lshl_b32 s3, s57, 17
    s_add_u32 s44, s16, s3
    s_addc_u32 s45, s17, 0
    s_and_b32 s45, s45, 0xffff
    s_mov_b32 s46, 131072
    s_mov_b32 s47, 0x20000
    s_lshl_b32 s3, s69, 1
    s_lshr_b32 s62, s56, 1
    s_add_u32 s3, s3, s62
    s_sub_u32 s3, 7, s3
    s_lshl_b32 s3, s3, 13
    s_and_b32 s62, s56, 1
    s_lshl_b32 s62, s62, 16
    s_add_u32 s3, s3, s62
    v_lshlrev_b32 v4, 7, v1
    buffer_load_dword v248, v4, s[44:47], s3 offen
    s_lshl_b32 s3, s57, 17
    s_add_u32 s44, s28, s3
    s_addc_u32 s45, s29, 0
    s_and_b32 s45, s45, 0xffff
    s_mov_b32 s46, 131072
    s_mov_b32 s47, 0x20000
    s_lshl_b32 s3, s69, 1
    s_lshr_b32 s62, s56, 1
    s_add_u32 s3, s3, s62
    s_sub_u32 s3, 7, s3
    s_lshl_b32 s3, s3, 13
    s_and_b32 s62, s56, 1
    s_lshl_b32 s62, s62, 16
    s_add_u32 s3, s3, s62
    v_lshlrev_b32 v4, 7, v1
    buffer_load_dword v248, v4, s[44:47], s3 offen
    s_endpgm
L_exit:
    s_endpgm
L_role_a2:
    s_mov_b32 s63, s68
    v_mov_b32 v6, 0
    v_mov_b32 v7, 0
    ds_write_b64 v6, v[6:7] offset:13312
    ds_write_b64 v6, v[6:7] offset:13320
    s_lshl_b32 s3, s58, 5
    s_add_u32 s3, s3, s57
    s_lshl_b32 s3, s3, 21
    s_add_u32 s3, s3, 1572864
    s_add_u32 s52, s10, s3
    s_addc_u32 s53, s11, 0
    s_and_b32 s53, s53, 0xffff
    s_mov_b32 s54, 172032
    s_mov_b32 s55, 0x20000
    s_add_u32 s4, s12, s3
    s_addc_u32 s5, s13, 0
    s_and_b32 s5, s5, 0xffff
    s_mov_b32 s6, 172032
    s_mov_b32 s7, 0x20000
    s_mov_b32 s48, s34
    s_and_b32 s49, s35, 0xffff
    s_mov_b32 s50, 4194304
    s_mov_b32 s51, 0x20000
    s_mov_b32 s64, 1000000
    s_movk_i32 s65, 0xfff
    s_mov_b32 s66, 0xfffff000
    s_mov_b32 s67, 0x3fb8aa3b
    v_lshlrev_b32 v22, 4, v1
    s_lshl_b32 s3, s56, 10
    v_add_u32 v0, s3, v22
    v_and_b32 v4, 1, v2
    v_bfe_u32 v5, v2, 1, 2
    v_cmp_eq_u32 vcc, 1, v4
    v_mov_b32 v6, 0xffff
    v_mov_b32 v7, 0xffff0000
    v_cndmask_b32 v8, v6, v7, vcc
    v_mov_b32 v6, 0x0c0c0100
    v_mov_b32 v7, 0x01000c0c
    v_cndmask_b32 v24, v6, v7, vcc
    v_mov_b32 v6, 0x0c0c0302
    v_mov_b32 v7, 0x03020c0c
    v_cndmask_b32 v25, v6, v7, vcc
    v_mov_b32 v6, 0x0c0c0c0c
    v_cmp_eq_u32 vcc, 0, v5
    s_nop 1
    v_cndmask_b32 v10, 0, v8, vcc
    v_cndmask_b32 v14, v6, v24, vcc
    v_cndmask_b32 v15, v6, v25, vcc
    v_cmp_eq_u32 vcc, 1, v5
    s_nop 1
    v_cndmask_b32 v11, 0, v8, vcc
    v_cndmask_b32 v16, v6, v24, vcc
    v_cndmask_b32 v17, v6, v25, vcc
    v_cmp_eq_u32 vcc, 2, v5
    s_nop 1
    v_cndmask_b32 v12, 0, v8, vcc
    v_cndmask_b32 v18, v6, v24, vcc
    v_cndmask_b32 v19, v6, v25, vcc
    v_cmp_eq_u32 vcc, 3, v5
    s_nop 1
    v_cndmask_b32 v13, 0, v8, vcc
    v_cndmask_b32 v20, v6, v24, vcc
    v_cndmask_b32 v21, v6, v25, vcc
    s_lshl_b32 s3, s58, 5
    s_add_u32 s3, s3, s57
    s_lshl_b32 s3, s3, 12
    s_add_u32 s3, s3, 65536
    s_lshl1_add_u32 s3, s57, s58
    s_lshl_b32 s3, s3, 11
    s_add_u32 s3, s3, 196608
    s_cmp_lg_u32 s56, 0
    s_cbranch_scc1 L_nowarm_18
    v_min_u32 v4, 15, v1
    v_lshlrev_b32 v4, 7, v4
    buffer_load_dword v71, v4, s[48:51], s3 offen
L_nowarm_18:
    s_lshl_b32 s3, s57, 17
    s_add_u32 s44, s16, s3
    s_addc_u32 s45, s17, 0
    s_and_b32 s45, s45, 0xffff
    s_mov_b32 s46, 131072
    s_mov_b32 s47, 0x20000
    s_waitcnt lgkmcnt(0)
    s_add_u32 s60, s60, 1
    v_mov_b32 v9, s60
    s_mov_b32 s0, 0
    s_cmp_lg_u32 s56, 3
    s_cbranch_scc1 L_noid_19
    s_getreg_b32 s3, hwreg(HW_REG_XCC_ID, 0, 4)
    s_xor_b32 s3, s3, s60
    v_mov_b32 v4, s3
    v_mov_b32 v5, s60
    s_and_b32 s3, s2, 7
    s_lshl_b32 s3, s3, 5
    s_lshr_b32 s0, s2, 3
    s_add_u32 s3, s3, s0
    s_lshl_b32 s3, s3, 3
    s_add_u32 s3, s3, 4096
    s_mov_b32 s0, 0
    v_mov_b32 v6, 0
    s_mov_b64 exec, 1
    buffer_store_dwordx2 v[4:5], v6, s[48:51], s3 offen
    s_mov_b64 exec, -1
L_noid_19:
    v_and_b32 v4, 3, v1
    v_lshlrev_b32 v4, 3, v4
    v_lshrrev_b32 v4, v4, v9
    s_mov_b32 s1, 0x10001
    v_bfe_u32 v5, v4, 1, 1
    v_bfe_u32 v6, v4, 0, 1
    v_lshl_or_b32 v24, v5, 16, v6
    v_bfe_u32 v5, v4, 3, 1
    v_bfe_u32 v6, v4, 2, 1
    v_lshl_or_b32 v25, v5, 16, v6
    v_bfe_u32 v5, v4, 5, 1
    v_bfe_u32 v6, v4, 4, 1
    v_lshl_or_b32 v26, v5, 16, v6
    v_bfe_u32 v5, v4, 7, 1
    v_bfe_u32 v6, v4, 6, 1
    v_lshl_or_b32 v27, v5, 16, v6
    s_barrier
    s_waitcnt vmcnt(7)
    s_add_u32 m0, s63, 8192
    s_nop 0
    buffer_load_dwordx4 v36, s[36:39], s61 offen nt lds
    s_add_u32 s61, s61, 0x8000
    s_waitcnt vmcnt(7)
    s_add_u32 m0, s63, 9216
    s_nop 0
    buffer_load_dwordx4 v37, s[36:39], s61 offen nt lds
    s_add_u32 s61, s61, 0x8000
    s_waitcnt vmcnt(7)
    s_add_u32 m0, s63, 10240
    s_nop 0
    buffer_load_dwordx4 v38, s[36:39], s61 offen nt lds
    s_add_u32 s61, s61, 0x8000
    s_waitcnt vmcnt(7)
    s_add_u32 m0, s63, 11264
    s_nop 0
    buffer_load_dwordx4 v39, s[36:39], s61 offen nt lds
    s_add_u32 s61, s61, 0x8000
    s_waitcnt vmcnt(7)
    s_add_u32 m0, s63, 12288
    s_nop 0
    buffer_load_dwordx4 v36, s[36:39], s61 offen nt lds
    s_add_u32 s61, s61, 0x8000
    s_waitcnt vmcnt(7)
    s_add_u32 m0, s63, 13312
    s_nop 0
    buffer_load_dwordx4 v37, s[36:39], s61 offen nt lds
    s_add_u32 s61, s61, 0x8000
    s_waitcnt vmcnt(7)
    s_add_u32 m0, s63, 14336
    s_nop 0
    buffer_load_dwordx4 v38, s[36:39], s61 offen nt lds
    s_add_u32 s61, s61, 0x8000
    s_waitcnt vmcnt(7)
    s_add_u32 m0, s63, 15360
    s_nop 0
    buffer_load_dwordx4 v39, s[36:39], s61 offen nt lds
    s_lshl_b32 s68, s57, 12
    s_add_u32 s68, s68, 196608
    s_waitcnt vmcnt(2)
    buffer_load_dwordx4 v[56:59], v22, s[48:51], s68 offen offset:0 sc1
    buffer_load_dwordx4 v[60:63], v22, s[48:51], s68 offen offset:1024 sc1
    buffer_load_dwordx4 v[64:67], v22, s[48:51], s68 offen offset:2048 sc1
    buffer_load_dwordx4 v[68:71], v22, s[48:51], s68 offen offset:3072 sc1
    s_waitcnt vmcnt(4)
    v_xor_b32 v4, v3, v2
    v_lshl_add_u32 v5, v2, 8, s63
    v_xor_b32 v6, 0, v4
    v_lshl_add_u32 v6, v6, 4, v5
    ds_read_b128 a[192:195], v6 offset:0
    ds_read_b128 a[208:211], v6 offset:4096
    ds_read_b128 a[224:227], v6 offset:8192
    ds_read_b128 a[240:243], v6 offset:12288
    v_xor_b32 v6, 4, v4
    v_lshl_add_u32 v6, v6, 4, v5
    ds_read_b128 a[196:199], v6 offset:0
    ds_read_b128 a[212:215], v6 offset:4096
    ds_read_b128 a[228:231], v6 offset:8192
    ds_read_b128 a[244:247], v6 offset:12288
    v_xor_b32 v6, 8, v4
    v_lshl_add_u32 v6, v6, 4, v5
    ds_read_b128 a[200:203], v6 offset:0
    ds_read_b128 a[216:219], v6 offset:4096
    ds_read_b128 a[232:235], v6 offset:8192
    ds_read_b128 a[248:251], v6 offset:12288
    v_xor_b32 v6, 12, v4
    v_lshl_add_u32 v6, v6, 4, v5
    ds_read_b128 a[204:207], v6 offset:0
    ds_read_b128 a[220:223], v6 offset:4096
    ds_read_b128 a[236:239], v6 offset:8192
    ds_read_b128 a[252:255], v6 offset:12288
    s_waitcnt vmcnt(0)
L_chk_20:
    v_xor_b32 v4, s60, v56
    v_bitop3_b32 v4, v4, v57, s60 bitop3:0xf6
    v_bitop3_b32 v4, v4, v58, s60 bitop3:0xf6
    v_bitop3_b32 v4, v4, v59, s60 bitop3:0xf6
    v_bitop3_b32 v4, v4, v60, s60 bitop3:0xf6
    v_bitop3_b32 v4, v4, v61, s60 bitop3:0xf6
    v_bitop3_b32 v4, v4, v62, s60 bitop3:0xf6
    v_bitop3_b32 v4, v4, v63, s60 bitop3:0xf6
    v_bitop3_b32 v4, v4, v64, s60 bitop3:0xf6
    v_bitop3_b32 v4, v4, v65, s60 bitop3:0xf6
    v_bitop3_b32 v4, v4, v66, s60 bitop3:0xf6
    v_bitop3_b32 v4, v4, v67, s60 bitop3:0xf6
    v_bitop3_b32 v4, v4, v68, s60 bitop3:0xf6
    v_bitop3_b32 v4, v4, v69, s60 bitop3:0xf6
    v_bitop3_b32 v4, v4, v70, s60 bitop3:0xf6
    v_bitop3_b32 v4, v4, v71, s60 bitop3:0xf6
    v_and_b32 v4, s65, v4
    v_cmp_ne_u32 vcc, 0, v4
    s_cbranch_vccz L_ok_21
    s_cmp_eq_u32 s64, 0
    s_cbranch_scc1 L_ok_21
    s_sub_u32 s64, s64, 1
    buffer_load_dwordx4 v[56:59], v22, s[48:51], s68 offen offset:0 sc1
    buffer_load_dwordx4 v[60:63], v22, s[48:51], s68 offen offset:1024 sc1
    buffer_load_dwordx4 v[64:67], v22, s[48:51], s68 offen offset:2048 sc1
    buffer_load_dwordx4 v[68:71], v22, s[48:51], s68 offen offset:3072 sc1
    s_waitcnt vmcnt(0)
    s_branch L_chk_20
L_ok_21:
    v_and_b32 v56, s66, v56
    v_and_b32 v57, s66, v57
    v_and_b32 v58, s66, v58
    v_and_b32 v59, s66, v59
    v_and_b32 v60, s66, v60
    v_and_b32 v61, s66, v61
    v_and_b32 v62, s66, v62
    v_and_b32 v63, s66, v63
    v_and_b32 v64, s66, v64
    v_and_b32 v65, s66, v65
    v_and_b32 v66, s66, v66
    v_and_b32 v67, s66, v67
    v_and_b32 v68, s66, v68
    v_and_b32 v69, s66, v69
    v_and_b32 v70, s66, v70
    v_and_b32 v71, s66, v71
    v_add_f32 v56, v56, v60
    v_add_f32 v64, v64, v68
    v_add_f32 v57, v57, v61
    v_add_f32 v65, v65, v69
    v_add_f32 v58, v58, v62
    v_add_f32 v66, v66, v70
    v_add_f32 v59, v59, v63
    v_add_f32 v67, v67, v71
    v_add_f32 v56, v56, v64
    v_add_f32 v57, v57, v65
    v_add_f32 v58, v58, v66
    v_add_f32 v59, v59, v67
    v_cvt_pk_bf16_f32 v56, v56, v57
    v_cvt_pk_bf16_f32 v57, v58, v59
    s_lshl_b32 s3, s56, 9
    s_add_u32 s3, s3, 10240
    v_lshrrev_b32 v4, 1, v3
    v_and_b32 v6, 1, v3
    v_lshlrev_b32 v4, 8, v4
    v_lshl_add_u32 v4, v6, 3, v4
    v_lshl_add_u32 v4, v2, 4, v4
    v_add_u32 v4, s3, v4
    ds_write_b64 v4, v[56:57]
    v_and_b32 v4, 1, v2
    v_lshlrev_b32 v4, 8, v4
    v_lshl_add_u32 v4, v3, 4, v4
    v_add_u32 v4, s3, v4
    s_waitcnt lgkmcnt(0)
    ds_read_b128 v[56:59], v4 offset:0
    ds_read_b128 v[60:63], v4 offset:64
    ds_read_b128 v[64:67], v4 offset:128
    ds_read_b128 v[68:71], v4 offset:192
    s_waitcnt lgkmcnt(0)
    v_mfma_f32_16x16x32_bf16 v[40:43], a[192:195], v[56:59], 0
    v_mfma_f32_16x16x32_bf16 v[40:43], a[196:199], v[60:63], v[40:43]
    v_mfma_f32_16x16x32_bf16 v[40:43], a[200:203], v[64:67], v[40:43]
    v_mfma_f32_16x16x32_bf16 v[40:43], a[204:207], v[68:71], v[40:43]
    v_mfma_f32_16x16x32_bf16 v[44:47], a[208:211], v[56:59], 0
    v_mfma_f32_16x16x32_bf16 v[44:47], a[212:215], v[60:63], v[44:47]
    v_mfma_f32_16x16x32_bf16 v[44:47], a[216:219], v[64:67], v[44:47]
    v_mfma_f32_16x16x32_bf16 v[44:47], a[220:223], v[68:71], v[44:47]
    v_mfma_f32_16x16x32_bf16 v[48:51], a[224:227], v[56:59], 0
    v_mfma_f32_16x16x32_bf16 v[48:51], a[228:231], v[60:63], v[48:51]
    v_mfma_f32_16x16x32_bf16 v[48:51], a[232:235], v[64:67], v[48:51]
    v_mfma_f32_16x16x32_bf16 v[48:51], a[236:239], v[68:71], v[48:51]
    v_mfma_f32_16x16x32_bf16 v[52:55], a[240:243], v[56:59], 0
    v_mfma_f32_16x16x32_bf16 v[52:55], a[244:247], v[60:63], v[52:55]
    v_mfma_f32_16x16x32_bf16 v[52:55], a[248:251], v[64:67], v[52:55]
    v_mfma_f32_16x16x32_bf16 v[52:55], a[252:255], v[68:71], v[52:55]
    s_lshl_b32 s3, s56, 7
    v_and_b32 v4, 1, v2
    v_lshlrev_b32 v4, 9, v4
    v_lshl_add_u32 v4, v3, 3, v4
    v_add_u32 v4, s3, v4
    v_cvt_pk_bf16_f32 v40, v40, v41
    v_cvt_pk_bf16_f32 v41, v42, v43
    ds_write_b64 v4, v[40:41] offset:12288
    v_cvt_pk_bf16_f32 v44, v44, v45
    v_cvt_pk_bf16_f32 v45, v46, v47
    ds_write_b64 v4, v[44:45] offset:12320
    v_cvt_pk_bf16_f32 v48, v48, v49
    v_cvt_pk_bf16_f32 v49, v50, v51
    ds_write_b64 v4, v[48:49] offset:12352
    v_cvt_pk_bf16_f32 v52, v52, v53
    v_cvt_pk_bf16_f32 v53, v54, v55
    ds_write_b64 v4, v[52:53] offset:12384
    v_bfe_u32 v5, v1, 3, 1
    v_and_b32 v6, 7, v1
    v_lshlrev_b32 v6, 4, v6
    v_lshl_add_u32 v4, v5, 9, v6
    v_add_u32 v4, s3, v4
    ds_read_b128 v[56:59], v4 offset:12288
    v_lshl_add_u32 v4, v5, 15, v6
    s_lshl_b32 s62, s57, 1
    s_add_u32 s62, s62, s58
    s_lshl_b32 s62, s62, 9
    s_add_u32 s62, s62, s3
    s_and_b32 s3, s3, 0
    s_add_u32 s3, s3, s62
    s_add_u32 s3, s3, 786432
    s_waitcnt lgkmcnt(0)
    v_lshrrev_b32 v5, 1, v56
    v_and_b32 v5, s1, v5
    v_add_u32 v56, v56, v5
    v_bfi_b32 v56, s1, v24, v56
    v_lshrrev_b32 v5, 1, v57
    v_and_b32 v5, s1, v5
    v_add_u32 v57, v57, v5
    v_bfi_b32 v57, s1, v25, v57
    v_lshrrev_b32 v5, 1, v58
    v_and_b32 v5, s1, v5
    v_add_u32 v58, v58, v5
    v_bfi_b32 v58, s1, v26, v58
    v_lshrrev_b32 v5, 1, v59
    v_and_b32 v5, s1, v5
    v_add_u32 v59, v59, v5
    v_bfi_b32 v59, s1, v27, v59
    s_mov_b64 exec, 0xffff
    buffer_store_dwordx4 v[56:59], v4, s[48:51], s3 offen sc1
    s_mov_b64 exec, -1
    s_nop 0
    s_and_b32 s3, s58, 1
    s_lshl_b32 s3, s3, 1
    s_and_b32 s70, s56, 1
    s_add_u32 s70, s70, s3
    s_lshr_b32 s71, s56, 1
    s_lshl_b32 s3, s71, 8
    s_add_u32 s3, s3, s70
    s_lshl_b32 s3, s3, 8
    v_lshlrev_b32 v4, 10, v3
    v_lshl_add_u32 v4, v2, 4, v4
    v_add_u32 v23, s3, v4
    s_mov_b32 s10, 0
    buffer_load_dwordx4 v[72:75], v0, s[52:55], s10 offen nt
    s_mov_b32 s10, 4096
    buffer_load_dwordx4 v[76:79], v0, s[52:55], s10 offen nt
    s_mov_b32 s10, 8192
    buffer_load_dwordx4 v[80:83], v0, s[52:55], s10 offen nt
    s_mov_b32 s10, 12288
    buffer_load_dwordx4 v[84:87], v0, s[52:55], s10 offen nt
    s_mov_b32 s10, 16384
    buffer_load_dwordx4 v[88:91], v0, s[52:55], s10 offen nt
    s_mov_b32 s10, 20480
    buffer_load_dwordx4 v[92:95], v0, s[52:55], s10 offen nt
    s_mov_b32 s10, 24576
    buffer_load_dwordx4 v[96:99], v0, s[52:55], s10 offen nt
    s_mov_b32 s10, 28672
    buffer_load_dwordx4 v[100:103], v0, s[52:55], s10 offen nt
    s_waitcnt vmcnt(7)
    s_mov_b32 s10, 32768
    buffer_load_dwordx4 v[104:107], v0, s[52:55], s10 offen nt
    s_waitcnt vmcnt(7)
    s_mov_b32 s10, 36864
    buffer_load_dwordx4 v[108:111], v0, s[52:55], s10 offen nt
    s_waitcnt vmcnt(7)
    s_mov_b32 s10, 40960
    buffer_load_dwordx4 v[112:115], v0, s[52:55], s10 offen nt
    s_waitcnt vmcnt(7)
    s_mov_b32 s10, 45056
    buffer_load_dwordx4 v[116:119], v0, s[52:55], s10 offen nt
    s_waitcnt vmcnt(7)
    s_mov_b32 s10, 49152
    buffer_load_dwordx4 v[120:123], v0, s[52:55], s10 offen nt
    s_waitcnt vmcnt(7)
    s_mov_b32 s10, 53248
    buffer_load_dwordx4 v[124:127], v0, s[52:55], s10 offen nt
    s_waitcnt vmcnt(7)
    s_mov_b32 s10, 57344
    buffer_load_dwordx4 v[128:131], v0, s[52:55], s10 offen nt
    s_waitcnt vmcnt(7)
    s_mov_b32 s10, 61440
    buffer_load_dwordx4 v[132:135], v0, s[52:55], s10 offen nt
    s_waitcnt vmcnt(6)
    s_and_b32 s3, s57, 3
    s_lshl1_add_u32 s3, s3, s58
    s_lshl2_add_u32 s3, s3, s56
    s_mul_i32 s3, s3, 3072
    s_lshr_b32 s62, s57, 2
    s_lshl_b32 s62, s62, 18
    s_add_u32 s3, s3, s62
    s_add_u32 s3, s3, 2097152
    v_min_u32 v4, 23, v1
    v_lshlrev_b32 v4, 7, v4
    buffer_load_dword v42, v4, s[48:51], s3 offen
    s_mov_b32 s10, 65536
    buffer_load_dwordx4 v[136:139], v0, s[52:55], s10 offen nt
    s_waitcnt vmcnt(7)
    s_mov_b32 s10, 69632
    buffer_load_dwordx4 v[140:143], v0, s[52:55], s10 offen nt
    s_waitcnt vmcnt(7)
    s_mov_b32 s10, 73728
    buffer_load_dwordx4 v[144:147], v0, s[52:55], s10 offen nt
    s_waitcnt vmcnt(7)
    s_mov_b32 s10, 77824
    buffer_load_dwordx4 v[148:151], v0, s[52:55], s10 offen nt
    s_waitcnt vmcnt(7)
    s_mov_b32 s10, 81920
    buffer_load_dwordx4 v[152:155], v0, s[52:55], s10 offen nt
    s_waitcnt vmcnt(7)
    s_mov_b32 s10, 86016
    buffer_load_dwordx4 v[156:159], v0, s[52:55], s10 offen nt
    s_waitcnt vmcnt(7)
    s_mov_b32 s10, 90112
    buffer_load_dwordx4 v[160:163], v0, s[52:55], s10 offen nt
    s_waitcnt vmcnt(7)
    s_mov_b32 s10, 94208
    buffer_load_dwordx4 v[164:167], v0, s[52:55], s10 offen nt
    s_waitcnt vmcnt(7)
    s_mov_b32 s10, 98304
    buffer_load_dwordx4 v[168:171], v0, s[52:55], s10 offen nt
    s_waitcnt vmcnt(7)
    s_mov_b32 s10, 102400
    buffer_load_dwordx4 v[172:175], v0, s[52:55], s10 offen nt
    s_waitcnt vmcnt(7)
    s_mov_b32 s10, 106496
    buffer_load_dwordx4 v[176:179], v0, s[52:55], s10 offen nt
    s_waitcnt vmcnt(7)
    s_mov_b32 s10, 110592
    buffer_load_dwordx4 v[180:183], v0, s[52:55], s10 offen nt
    s_and_b32 s3, s2, 7
    s_lshl_b32 s3, s3, 8
    s_add_u32 s3, s3, 4096
    v_and_b32 v4, 31, v1
    v_lshlrev_b32 v4, 3, v4
    buffer_load_dwordx2 v[40:41], v4, s[48:51], s3 offen sc1
    s_lshl_b32 s68, s57, 12
    s_add_u32 s68, s68, 65536
    buffer_load_dwordx4 v[56:59], v22, s[48:51], s68 offen offset:0 sc1
    buffer_load_dwordx4 v[60:63], v22, s[48:51], s68 offen offset:1024 sc1
    buffer_load_dwordx4 v[64:67], v22, s[48:51], s68 offen offset:2048 sc1
    buffer_load_dwordx4 v[68:71], v22, s[48:51], s68 offen offset:3072 sc1
    s_mov_b32 s10, 114688
    buffer_load_dwordx4 v[184:187], v0, s[52:55], s10 offen nt
    s_mov_b32 s10, 118784
    buffer_load_dwordx4 v[188:191], v0, s[52:55], s10 offen nt
    s_lshl1_add_u32 s3, s57, s58
    s_mul_i32 s3, s3, 3
    s_add_u32 s3, s3, s59
    s_lshl_b32 s3, s3, 10
    s_add_u32 s3, s3, 524288
    s_cmp_lg_u32 s56, 0
    s_cbranch_scc1 L_nowarm_22
    v_min_u32 v4, 4, v1
    v_lshlrev_b32 v4, 7, v4
    buffer_load_dword a188, v4, s[48:51], s3 offen
L_nowarm_22:
    s_mov_b32 s10, 122880
    buffer_load_dwordx4 v[192:195], v0, s[52:55], s10 offen nt
    s_mov_b32 s10, 126976
    buffer_load_dwordx4 v[196:199], v0, s[52:55], s10 offen nt
    s_mov_b32 s10, 131072
    buffer_load_dwordx4 v[200:203], v0, s[52:55], s10 offen nt
    s_mov_b32 s10, 135168
    buffer_load_dwordx4 v[204:207], v0, s[52:55], s10 offen nt
    s_mov_b32 s10, 139264
    buffer_load_dwordx4 v[208:211], v0, s[52:55], s10 offen nt
    s_mov_b32 s10, 143360
    buffer_load_dwordx4 v[212:215], v0, s[52:55], s10 offen nt
    s_mov_b32 s10, 147456
    buffer_load_dwordx4 v[216:219], v0, s[52:55], s10 offen nt
    s_mov_b32 s10, 151552
    buffer_load_dwordx4 v[220:223], v0, s[52:55], s10 offen nt
    s_mov_b32 s10, 155648
    buffer_load_dwordx4 v[224:227], v0, s[52:55], s10 offen nt
    s_mov_b32 s10, 159744
    buffer_load_dwordx4 v[228:231], v0, s[52:55], s10 offen nt
    s_mov_b32 s10, 163840
    buffer_load_dwordx4 v[232:235], v0, s[52:55], s10 offen nt
    s_waitcnt vmcnt(13)
L_chk_23:
    v_xor_b32 v4, s60, v56
    v_bitop3_b32 v4, v4, v57, s60 bitop3:0xf6
    v_bitop3_b32 v4, v4, v58, s60 bitop3:0xf6
    v_bitop3_b32 v4, v4, v59, s60 bitop3:0xf6
    v_bitop3_b32 v4, v4, v60, s60 bitop3:0xf6
    v_bitop3_b32 v4, v4, v61, s60 bitop3:0xf6
    v_bitop3_b32 v4, v4, v62, s60 bitop3:0xf6
    v_bitop3_b32 v4, v4, v63, s60 bitop3:0xf6
    v_bitop3_b32 v4, v4, v64, s60 bitop3:0xf6
    v_bitop3_b32 v4, v4, v65, s60 bitop3:0xf6
    v_bitop3_b32 v4, v4, v66, s60 bitop3:0xf6
    v_bitop3_b32 v4, v4, v67, s60 bitop3:0xf6
    v_bitop3_b32 v4, v4, v68, s60 bitop3:0xf6
    v_bitop3_b32 v4, v4, v69, s60 bitop3:0xf6
    v_bitop3_b32 v4, v4, v70, s60 bitop3:0xf6
    v_bitop3_b32 v4, v4, v71, s60 bitop3:0xf6
    v_and_b32 v4, s65, v4
    v_cmp_ne_u32 vcc, 0, v4
    s_cbranch_vccz L_ok_24
    s_cmp_eq_u32 s64, 0
    s_cbranch_scc1 L_ok_24
    s_sub_u32 s64, s64, 1
    buffer_load_dwordx4 v[56:59], v22, s[48:51], s68 offen offset:0 sc1
    buffer_load_dwordx4 v[60:63], v22, s[48:51], s68 offen offset:1024 sc1
    buffer_load_dwordx4 v[64:67], v22, s[48:51], s68 offen offset:2048 sc1
    buffer_load_dwordx4 v[68:71], v22, s[48:51], s68 offen offset:3072 sc1
    s_waitcnt vmcnt(0)
    s_branch L_chk_23
L_ok_24:
    s_getreg_b32 s3, hwreg(HW_REG_XCC_ID, 0, 4)
    s_xor_b32 s3, s3, s60
    v_xor_b32 v4, s3, v40
    v_bitop3_b32 v4, v4, v41, s60 bitop3:0xf6
    v_cmp_ne_u32 vcc, 0, v4
    s_cmp_eq_u64 vcc, 0
    s_cselect_b32 s0, 1, 0
    v_and_b32 v56, s66, v56
    v_and_b32 v57, s66, v57
    v_and_b32 v58, s66, v58
    v_and_b32 v59, s66, v59
    v_and_b32 v60, s66, v60
    v_and_b32 v61, s66, v61
    v_and_b32 v62, s66, v62
    v_and_b32 v63, s66, v63
    v_and_b32 v64, s66, v64
    v_and_b32 v65, s66, v65
    v_and_b32 v66, s66, v66
    v_and_b32 v67, s66, v67
    v_and_b32 v68, s66, v68
    v_and_b32 v69, s66, v69
    v_and_b32 v70, s66, v70
    v_and_b32 v71, s66, v71
    v_add_f32 v56, v56, v60
    v_add_f32 v64, v64, v68
    v_add_f32 v57, v57, v61
    v_add_f32 v65, v65, v69
    v_add_f32 v58, v58, v62
    v_add_f32 v66, v66, v70
    v_add_f32 v59, v59, v63
    v_add_f32 v67, v67, v71
    v_add_f32 v56, v56, v64
    v_add_f32 v57, v57, v65
    v_add_f32 v58, v58, v66
    v_add_f32 v59, v59, v67
    v_cvt_pk_bf16_f32 v56, v56, v57
    v_cvt_pk_bf16_f32 v57, v58, v59
    s_lshl_b32 s3, s56, 9
    s_add_u32 s3, s3, 8192
    v_lshrrev_b32 v4, 1, v3
    v_and_b32 v6, 1, v3
    v_lshlrev_b32 v4, 8, v4
    v_lshl_add_u32 v4, v6, 3, v4
    v_lshl_add_u32 v4, v2, 4, v4
    v_add_u32 v4, s3, v4
    ds_write_b64 v4, v[56:57]
    s_lshl_b32 s62, s58, 8
    s_add_u32 s3, s3, s62
    v_lshl_add_u32 v4, v2, 4, s3
    s_waitcnt lgkmcnt(0)
    ds_read_b128 v[36:39], v4
    s_waitcnt lgkmcnt(0)
    s_mov_b32 s10, 167936
    buffer_load_dwordx4 v[236:239], v0, s[52:55], s10 offen nt
    s_mov_b32 s10, 0
    buffer_load_dwordx4 a[0:3], v0, s[4:7], s10 offen nt
    v_dot2_f32_bf16 v40, v72, v36, 0
    v_dot2_f32_bf16 v41, v76, v36, 0
    v_dot2_f32_bf16 v42, v80, v36, 0
    v_dot2_f32_bf16 v43, v84, v36, 0
    v_dot2c_f32_bf16 v40, v73, v37
    v_dot2c_f32_bf16 v41, v77, v37
    v_dot2c_f32_bf16 v42, v81, v37
    v_dot2c_f32_bf16 v43, v85, v37
    v_dot2c_f32_bf16 v40, v74, v38
    v_dot2c_f32_bf16 v41, v78, v38
    v_dot2c_f32_bf16 v42, v82, v38
    v_dot2c_f32_bf16 v43, v86, v38
    v_dot2c_f32_bf16 v40, v75, v39
    v_dot2c_f32_bf16 v41, v79, v39
    v_dot2c_f32_bf16 v42, v83, v39
    v_dot2c_f32_bf16 v43, v87, v39
    v_add_f32_dpp v40, v40, v40 row_ror:8 row_mask:0xf bank_mask:0x3
    v_add_f32_dpp v41, v41, v41 row_ror:8 row_mask:0xf bank_mask:0x3
    s_nop 0
    v_add_f32_dpp v40, v42, v42 row_ror:8 row_mask:0xf bank_mask:0xc
    v_add_f32_dpp v41, v43, v43 row_ror:8 row_mask:0xf bank_mask:0xc
    s_nop 0
    v_add_f32_dpp v44, v40, v40 row_shl:4 row_mask:0xf bank_mask:0x5
    s_nop 1
    v_add_f32_dpp v44, v41, v41 row_shr:4 row_mask:0xf bank_mask:0xa
    s_nop 1
    v_add_f32_dpp v44, v44, v44 quad_perm:[1,0,3,2] row_mask:0xf bank_mask:0xf
    s_nop 1
    v_add_f32_dpp v44, v44, v44 quad_perm:[2,3,0,1] row_mask:0xf bank_mask:0xf
    v_cvt_pk_bf16_f32 v44, v44, v44
    v_and_b32 v44, 0xffff0000, v44
    v_mul_f32 v44, 0x3db504f3, v44
    v_cvt_pk_bf16_f32 v44, v44, v44
    v_and_b32 v44, 0xffff0000, v44
    v_mov_b32 v8, v44
    s_mov_b32 s10, 4096
    buffer_load_dwordx4 a[4:7], v0, s[4:7], s10 offen nt
    s_mov_b32 s10, 8192
    buffer_load_dwordx4 a[8:11], v0, s[4:7], s10 offen nt
    v_dot2_f32_bf16 v40, v88, v36, 0
    v_dot2_f32_bf16 v41, v92, v36, 0
    v_dot2_f32_bf16 v42, v96, v36, 0
    v_dot2_f32_bf16 v43, v100, v36, 0
    v_dot2c_f32_bf16 v40, v89, v37
    v_dot2c_f32_bf16 v41, v93, v37
    v_dot2c_f32_bf16 v42, v97, v37
    v_dot2c_f32_bf16 v43, v101, v37
    v_dot2c_f32_bf16 v40, v90, v38
    v_dot2c_f32_bf16 v41, v94, v38
    v_dot2c_f32_bf16 v42, v98, v38
    v_dot2c_f32_bf16 v43, v102, v38
    v_dot2c_f32_bf16 v40, v91, v39
    v_dot2c_f32_bf16 v41, v95, v39
    v_dot2c_f32_bf16 v42, v99, v39
    v_dot2c_f32_bf16 v43, v103, v39
    v_add_f32_dpp v40, v40, v40 row_ror:8 row_mask:0xf bank_mask:0x3
    v_add_f32_dpp v41, v41, v41 row_ror:8 row_mask:0xf bank_mask:0x3
    s_nop 0
    v_add_f32_dpp v40, v42, v42 row_ror:8 row_mask:0xf bank_mask:0xc
    v_add_f32_dpp v41, v43, v43 row_ror:8 row_mask:0xf bank_mask:0xc
    s_nop 0
    v_add_f32_dpp v45, v40, v40 row_shl:4 row_mask:0xf bank_mask:0x5
    s_nop 1
    v_add_f32_dpp v45, v41, v41 row_shr:4 row_mask:0xf bank_mask:0xa
    s_nop 1
    v_add_f32_dpp v45, v45, v45 quad_perm:[1,0,3,2] row_mask:0xf bank_mask:0xf
    s_nop 1
    v_add_f32_dpp v45, v45, v45 quad_perm:[2,3,0,1] row_mask:0xf bank_mask:0xf
    v_cvt_pk_bf16_f32 v45, v45, v45
    v_and_b32 v45, 0xffff0000, v45
    v_mul_f32 v45, 0x3db504f3, v45
    v_cvt_pk_bf16_f32 v45, v45, v45
    v_and_b32 v45, 0xffff0000, v45
    v_max_f32 v8, v8, v45
    s_waitcnt vmcnt(16)
    s_mov_b32 s10, 12288
    buffer_load_dwordx4 a[12:15], v0, s[4:7], s10 offen nt
    s_waitcnt vmcnt(16)
    s_mov_b32 s10, 16384
    buffer_load_dwordx4 a[16:19], v0, s[4:7], s10 offen nt
    v_dot2_f32_bf16 v40, v104, v36, 0
    v_dot2_f32_bf16 v41, v108, v36, 0
    v_dot2_f32_bf16 v42, v112, v36, 0
    v_dot2_f32_bf16 v43, v116, v36, 0
    v_dot2c_f32_bf16 v40, v105, v37
    v_dot2c_f32_bf16 v41, v109, v37
    v_dot2c_f32_bf16 v42, v113, v37
    v_dot2c_f32_bf16 v43, v117, v37
    v_dot2c_f32_bf16 v40, v106, v38
    v_dot2c_f32_bf16 v41, v110, v38
    v_dot2c_f32_bf16 v42, v114, v38
    v_dot2c_f32_bf16 v43, v118, v38
    v_dot2c_f32_bf16 v40, v107, v39
    v_dot2c_f32_bf16 v41, v111, v39
    v_dot2c_f32_bf16 v42, v115, v39
    v_dot2c_f32_bf16 v43, v119, v39
    v_add_f32_dpp v40, v40, v40 row_ror:8 row_mask:0xf bank_mask:0x3
    v_add_f32_dpp v41, v41, v41 row_ror:8 row_mask:0xf bank_mask:0x3
    s_nop 0
    v_add_f32_dpp v40, v42, v42 row_ror:8 row_mask:0xf bank_mask:0xc
    v_add_f32_dpp v41, v43, v43 row_ror:8 row_mask:0xf bank_mask:0xc
    s_nop 0
    v_add_f32_dpp v46, v40, v40 row_shl:4 row_mask:0xf bank_mask:0x5
    s_nop 1
    v_add_f32_dpp v46, v41, v41 row_shr:4 row_mask:0xf bank_mask:0xa
    s_nop 1
    v_add_f32_dpp v46, v46, v46 quad_perm:[1,0,3,2] row_mask:0xf bank_mask:0xf
    s_nop 1
    v_add_f32_dpp v46, v46, v46 quad_perm:[2,3,0,1] row_mask:0xf bank_mask:0xf
    v_cvt_pk_bf16_f32 v46, v46, v46
    v_and_b32 v46, 0xffff0000, v46
    v_mul_f32 v46, 0x3db504f3, v46
    v_cvt_pk_bf16_f32 v46, v46, v46
    v_and_b32 v46, 0xffff0000, v46
    v_max_f32 v8, v8, v46
    s_waitcnt vmcnt(16)
    s_mov_b32 s10, 20480
    buffer_load_dwordx4 a[20:23], v0, s[4:7], s10 offen nt
    s_waitcnt vmcnt(16)
    s_mov_b32 s10, 24576
    buffer_load_dwordx4 a[24:27], v0, s[4:7], s10 offen nt
    v_dot2_f32_bf16 v40, v120, v36, 0
    v_dot2_f32_bf16 v41, v124, v36, 0
    v_dot2_f32_bf16 v42, v128, v36, 0
    v_dot2_f32_bf16 v43, v132, v36, 0
    v_dot2c_f32_bf16 v40, v121, v37
    v_dot2c_f32_bf16 v41, v125, v37
    v_dot2c_f32_bf16 v42, v129, v37
    v_dot2c_f32_bf16 v43, v133, v37
    v_dot2c_f32_bf16 v40, v122, v38
    v_dot2c_f32_bf16 v41, v126, v38
    v_dot2c_f32_bf16 v42, v130, v38
    v_dot2c_f32_bf16 v43, v134, v38
    v_dot2c_f32_bf16 v40, v123, v39
    v_dot2c_f32_bf16 v41, v127, v39
    v_dot2c_f32_bf16 v42, v131, v39
    v_dot2c_f32_bf16 v43, v135, v39
    v_add_f32_dpp v40, v40, v40 row_ror:8 row_mask:0xf bank_mask:0x3
    v_add_f32_dpp v41, v41, v41 row_ror:8 row_mask:0xf bank_mask:0x3
    s_nop 0
    v_add_f32_dpp v40, v42, v42 row_ror:8 row_mask:0xf bank_mask:0xc
    v_add_f32_dpp v41, v43, v43 row_ror:8 row_mask:0xf bank_mask:0xc
    s_nop 0
    v_add_f32_dpp v47, v40, v40 row_shl:4 row_mask:0xf bank_mask:0x5
    s_nop 1
    v_add_f32_dpp v47, v41, v41 row_shr:4 row_mask:0xf bank_mask:0xa
    s_nop 1
    v_add_f32_dpp v47, v47, v47 quad_perm:[1,0,3,2] row_mask:0xf bank_mask:0xf
    s_nop 1
    v_add_f32_dpp v47, v47, v47 quad_perm:[2,3,0,1] row_mask:0xf bank_mask:0xf
    v_cvt_pk_bf16_f32 v47, v47, v47
    v_and_b32 v47, 0xffff0000, v47
    v_mul_f32 v47, 0x3db504f3, v47
    v_cvt_pk_bf16_f32 v47, v47, v47
    v_and_b32 v47, 0xffff0000, v47
    v_max_f32 v8, v8, v47
    s_waitcnt vmcnt(16)
    s_mov_b32 s10, 28672
    buffer_load_dwordx4 a[28:31], v0, s[4:7], s10 offen nt
    s_waitcnt vmcnt(16)
    s_mov_b32 s10, 32768
    buffer_load_dwordx4 a[32:35], v0, s[4:7], s10 offen nt
    v_dot2_f32_bf16 v40, v136, v36, 0
    v_dot2_f32_bf16 v41, v140, v36, 0
    v_dot2_f32_bf16 v42, v144, v36, 0
    v_dot2_f32_bf16 v43, v148, v36, 0
    v_dot2c_f32_bf16 v40, v137, v37
    v_dot2c_f32_bf16 v41, v141, v37
    v_dot2c_f32_bf16 v42, v145, v37
    v_dot2c_f32_bf16 v43, v149, v37
    v_dot2c_f32_bf16 v40, v138, v38
    v_dot2c_f32_bf16 v41, v142, v38
    v_dot2c_f32_bf16 v42, v146, v38
    v_dot2c_f32_bf16 v43, v150, v38
    v_dot2c_f32_bf16 v40, v139, v39
    v_dot2c_f32_bf16 v41, v143, v39
    v_dot2c_f32_bf16 v42, v147, v39
    v_dot2c_f32_bf16 v43, v151, v39
    v_add_f32_dpp v40, v40, v40 row_ror:8 row_mask:0xf bank_mask:0x3
    v_add_f32_dpp v41, v41, v41 row_ror:8 row_mask:0xf bank_mask:0x3
    s_nop 0
    v_add_f32_dpp v40, v42, v42 row_ror:8 row_mask:0xf bank_mask:0xc
    v_add_f32_dpp v41, v43, v43 row_ror:8 row_mask:0xf bank_mask:0xc
    s_nop 0
    v_add_f32_dpp v48, v40, v40 row_shl:4 row_mask:0xf bank_mask:0x5
    s_nop 1
    v_add_f32_dpp v48, v41, v41 row_shr:4 row_mask:0xf bank_mask:0xa
    s_nop 1
    v_add_f32_dpp v48, v48, v48 quad_perm:[1,0,3,2] row_mask:0xf bank_mask:0xf
    s_nop 1
    v_add_f32_dpp v48, v48, v48 quad_perm:[2,3,0,1] row_mask:0xf bank_mask:0xf
    v_cvt_pk_bf16_f32 v48, v48, v48
    v_and_b32 v48, 0xffff0000, v48
    v_mul_f32 v48, 0x3db504f3, v48
    v_cvt_pk_bf16_f32 v48, v48, v48
    v_and_b32 v48, 0xffff0000, v48
    v_max_f32 v8, v8, v48
    s_waitcnt vmcnt(16)
    s_mov_b32 s10, 36864
    buffer_load_dwordx4 a[36:39], v0, s[4:7], s10 offen nt
    s_waitcnt vmcnt(16)
    s_mov_b32 s10, 40960
    buffer_load_dwordx4 a[40:43], v0, s[4:7], s10 offen nt
    v_dot2_f32_bf16 v40, v152, v36, 0
    v_dot2_f32_bf16 v41, v156, v36, 0
    v_dot2_f32_bf16 v42, v160, v36, 0
    v_dot2_f32_bf16 v43, v164, v36, 0
    v_dot2c_f32_bf16 v40, v153, v37
    v_dot2c_f32_bf16 v41, v157, v37
    v_dot2c_f32_bf16 v42, v161, v37
    v_dot2c_f32_bf16 v43, v165, v37
    v_dot2c_f32_bf16 v40, v154, v38
    v_dot2c_f32_bf16 v41, v158, v38
    v_dot2c_f32_bf16 v42, v162, v38
    v_dot2c_f32_bf16 v43, v166, v38
    v_dot2c_f32_bf16 v40, v155, v39
    v_dot2c_f32_bf16 v41, v159, v39
    v_dot2c_f32_bf16 v42, v163, v39
    v_dot2c_f32_bf16 v43, v167, v39
    v_add_f32_dpp v40, v40, v40 row_ror:8 row_mask:0xf bank_mask:0x3
    v_add_f32_dpp v41, v41, v41 row_ror:8 row_mask:0xf bank_mask:0x3
    s_nop 0
    v_add_f32_dpp v40, v42, v42 row_ror:8 row_mask:0xf bank_mask:0xc
    v_add_f32_dpp v41, v43, v43 row_ror:8 row_mask:0xf bank_mask:0xc
    s_nop 0
    v_add_f32_dpp v49, v40, v40 row_shl:4 row_mask:0xf bank_mask:0x5
    s_nop 1
    v_add_f32_dpp v49, v41, v41 row_shr:4 row_mask:0xf bank_mask:0xa
    s_nop 1
    v_add_f32_dpp v49, v49, v49 quad_perm:[1,0,3,2] row_mask:0xf bank_mask:0xf
    s_nop 1
    v_add_f32_dpp v49, v49, v49 quad_perm:[2,3,0,1] row_mask:0xf bank_mask:0xf
    v_cvt_pk_bf16_f32 v49, v49, v49
    v_and_b32 v49, 0xffff0000, v49
    v_mul_f32 v49, 0x3db504f3, v49
    v_cvt_pk_bf16_f32 v49, v49, v49
    v_and_b32 v49, 0xffff0000, v49
    v_max_f32 v8, v8, v49
    s_waitcnt vmcnt(16)
    s_mov_b32 s10, 45056
    buffer_load_dwordx4 a[44:47], v0, s[4:7], s10 offen nt
    s_waitcnt vmcnt(16)
    s_mov_b32 s10, 49152
    buffer_load_dwordx4 a[48:51], v0, s[4:7], s10 offen nt
    v_dot2_f32_bf16 v40, v168, v36, 0
    v_dot2_f32_bf16 v41, v172, v36, 0
    v_dot2_f32_bf16 v42, v176, v36, 0
    v_dot2_f32_bf16 v43, v180, v36, 0
    v_dot2c_f32_bf16 v40, v169, v37
    v_dot2c_f32_bf16 v41, v173, v37
    v_dot2c_f32_bf16 v42, v177, v37
    v_dot2c_f32_bf16 v43, v181, v37
    v_dot2c_f32_bf16 v40, v170, v38
    v_dot2c_f32_bf16 v41, v174, v38
    v_dot2c_f32_bf16 v42, v178, v38
    v_dot2c_f32_bf16 v43, v182, v38
    v_dot2c_f32_bf16 v40, v171, v39
    v_dot2c_f32_bf16 v41, v175, v39
    v_dot2c_f32_bf16 v42, v179, v39
    v_dot2c_f32_bf16 v43, v183, v39
    v_add_f32_dpp v40, v40, v40 row_ror:8 row_mask:0xf bank_mask:0x3
    v_add_f32_dpp v41, v41, v41 row_ror:8 row_mask:0xf bank_mask:0x3
    s_nop 0
    v_add_f32_dpp v40, v42, v42 row_ror:8 row_mask:0xf bank_mask:0xc
    v_add_f32_dpp v41, v43, v43 row_ror:8 row_mask:0xf bank_mask:0xc
    s_nop 0
    v_add_f32_dpp v50, v40, v40 row_shl:4 row_mask:0xf bank_mask:0x5
    s_nop 1
    v_add_f32_dpp v50, v41, v41 row_shr:4 row_mask:0xf bank_mask:0xa
    s_nop 1
    v_add_f32_dpp v50, v50, v50 quad_perm:[1,0,3,2] row_mask:0xf bank_mask:0xf
    s_nop 1
    v_add_f32_dpp v50, v50, v50 quad_perm:[2,3,0,1] row_mask:0xf bank_mask:0xf
    v_cvt_pk_bf16_f32 v50, v50, v50
    v_and_b32 v50, 0xffff0000, v50
    v_mul_f32 v50, 0x3db504f3, v50
    v_cvt_pk_bf16_f32 v50, v50, v50
    v_and_b32 v50, 0xffff0000, v50
    v_max_f32 v8, v8, v50
    s_waitcnt vmcnt(16)
    s_mov_b32 s10, 53248
    buffer_load_dwordx4 a[52:55], v0, s[4:7], s10 offen nt
    s_waitcnt vmcnt(16)
    s_mov_b32 s10, 57344
    buffer_load_dwordx4 a[56:59], v0, s[4:7], s10 offen nt
    v_dot2_f32_bf16 v40, v184, v36, 0
    v_dot2_f32_bf16 v41, v188, v36, 0
    v_dot2_f32_bf16 v42, v192, v36, 0
    v_dot2_f32_bf16 v43, v196, v36, 0
    v_dot2c_f32_bf16 v40, v185, v37
    v_dot2c_f32_bf16 v41, v189, v37
    v_dot2c_f32_bf16 v42, v193, v37
    v_dot2c_f32_bf16 v43, v197, v37
    v_dot2c_f32_bf16 v40, v186, v38
    v_dot2c_f32_bf16 v41, v190, v38
    v_dot2c_f32_bf16 v42, v194, v38
    v_dot2c_f32_bf16 v43, v198, v38
    v_dot2c_f32_bf16 v40, v187, v39
    v_dot2c_f32_bf16 v41, v191, v39
    v_dot2c_f32_bf16 v42, v195, v39
    v_dot2c_f32_bf16 v43, v199, v39
    v_add_f32_dpp v40, v40, v40 row_ror:8 row_mask:0xf bank_mask:0x3
    v_add_f32_dpp v41, v41, v41 row_ror:8 row_mask:0xf bank_mask:0x3
    s_nop 0
    v_add_f32_dpp v40, v42, v42 row_ror:8 row_mask:0xf bank_mask:0xc
    v_add_f32_dpp v41, v43, v43 row_ror:8 row_mask:0xf bank_mask:0xc
    s_nop 0
    v_add_f32_dpp v51, v40, v40 row_shl:4 row_mask:0xf bank_mask:0x5
    s_nop 1
    v_add_f32_dpp v51, v41, v41 row_shr:4 row_mask:0xf bank_mask:0xa
    s_nop 1
    v_add_f32_dpp v51, v51, v51 quad_perm:[1,0,3,2] row_mask:0xf bank_mask:0xf
    s_nop 1
    v_add_f32_dpp v51, v51, v51 quad_perm:[2,3,0,1] row_mask:0xf bank_mask:0xf
    v_cvt_pk_bf16_f32 v51, v51, v51
    v_and_b32 v51, 0xffff0000, v51
    v_mul_f32 v51, 0x3db504f3, v51
    v_cvt_pk_bf16_f32 v51, v51, v51
    v_and_b32 v51, 0xffff0000, v51
    v_max_f32 v8, v8, v51
    s_waitcnt vmcnt(16)
    s_mov_b32 s10, 61440
    buffer_load_dwordx4 a[60:63], v0, s[4:7], s10 offen nt
    s_waitcnt vmcnt(16)
    s_mov_b32 s10, 65536
    buffer_load_dwordx4 a[64:67], v0, s[4:7], s10 offen nt
    v_dot2_f32_bf16 v40, v200, v36, 0
    v_dot2_f32_bf16 v41, v204, v36, 0
    v_dot2_f32_bf16 v42, v208, v36, 0
    v_dot2_f32_bf16 v43, v212, v36, 0
    v_dot2c_f32_bf16 v40, v201, v37
    v_dot2c_f32_bf16 v41, v205, v37
    v_dot2c_f32_bf16 v42, v209, v37
    v_dot2c_f32_bf16 v43, v213, v37
    v_dot2c_f32_bf16 v40, v202, v38
    v_dot2c_f32_bf16 v41, v206, v38
    v_dot2c_f32_bf16 v42, v210, v38
    v_dot2c_f32_bf16 v43, v214, v38
    v_dot2c_f32_bf16 v40, v203, v39
    v_dot2c_f32_bf16 v41, v207, v39
    v_dot2c_f32_bf16 v42, v211, v39
    v_dot2c_f32_bf16 v43, v215, v39
    v_add_f32_dpp v40, v40, v40 row_ror:8 row_mask:0xf bank_mask:0x3
    v_add_f32_dpp v41, v41, v41 row_ror:8 row_mask:0xf bank_mask:0x3
    s_nop 0
    v_add_f32_dpp v40, v42, v42 row_ror:8 row_mask:0xf bank_mask:0xc
    v_add_f32_dpp v41, v43, v43 row_ror:8 row_mask:0xf bank_mask:0xc
    s_nop 0
    v_add_f32_dpp v52, v40, v40 row_shl:4 row_mask:0xf bank_mask:0x5
    s_nop 1
    v_add_f32_dpp v52, v41, v41 row_shr:4 row_mask:0xf bank_mask:0xa
    s_nop 1
    v_add_f32_dpp v52, v52, v52 quad_perm:[1,0,3,2] row_mask:0xf bank_mask:0xf
    s_nop 1
    v_add_f32_dpp v52, v52, v52 quad_perm:[2,3,0,1] row_mask:0xf bank_mask:0xf
    v_cvt_pk_bf16_f32 v52, v52, v52
    v_and_b32 v52, 0xffff0000, v52
    v_mul_f32 v52, 0x3db504f3, v52
    v_cvt_pk_bf16_f32 v52, v52, v52
    v_and_b32 v52, 0xffff0000, v52
    v_max_f32 v8, v8, v52
    s_waitcnt vmcnt(16)
    s_mov_b32 s10, 69632
    buffer_load_dwordx4 a[68:71], v0, s[4:7], s10 offen nt
    s_waitcnt vmcnt(16)
    s_mov_b32 s10, 73728
    buffer_load_dwordx4 a[72:75], v0, s[4:7], s10 offen nt
    v_dot2_f32_bf16 v40, v216, v36, 0
    v_dot2_f32_bf16 v41, v220, v36, 0
    v_dot2_f32_bf16 v42, v224, v36, 0
    v_dot2_f32_bf16 v43, v228, v36, 0
    v_dot2c_f32_bf16 v40, v217, v37
    v_dot2c_f32_bf16 v41, v221, v37
    v_dot2c_f32_bf16 v42, v225, v37
    v_dot2c_f32_bf16 v43, v229, v37
    v_dot2c_f32_bf16 v40, v218, v38
    v_dot2c_f32_bf16 v41, v222, v38
    v_dot2c_f32_bf16 v42, v226, v38
    v_dot2c_f32_bf16 v43, v230, v38
    v_dot2c_f32_bf16 v40, v219, v39
    v_dot2c_f32_bf16 v41, v223, v39
    v_dot2c_f32_bf16 v42, v227, v39
    v_dot2c_f32_bf16 v43, v231, v39
    v_add_f32_dpp v40, v40, v40 row_ror:8 row_mask:0xf bank_mask:0x3
    v_add_f32_dpp v41, v41, v41 row_ror:8 row_mask:0xf bank_mask:0x3
    s_nop 0
    v_add_f32_dpp v40, v42, v42 row_ror:8 row_mask:0xf bank_mask:0xc
    v_add_f32_dpp v41, v43, v43 row_ror:8 row_mask:0xf bank_mask:0xc
    s_nop 0
    v_add_f32_dpp v53, v40, v40 row_shl:4 row_mask:0xf bank_mask:0x5
    s_nop 1
    v_add_f32_dpp v53, v41, v41 row_shr:4 row_mask:0xf bank_mask:0xa
    s_nop 1
    v_add_f32_dpp v53, v53, v53 quad_perm:[1,0,3,2] row_mask:0xf bank_mask:0xf
    s_nop 1
    v_add_f32_dpp v53, v53, v53 quad_perm:[2,3,0,1] row_mask:0xf bank_mask:0xf
    v_cvt_pk_bf16_f32 v53, v53, v53
    v_and_b32 v53, 0xffff0000, v53
    v_mul_f32 v53, 0x3db504f3, v53
    v_cvt_pk_bf16_f32 v53, v53, v53
    v_and_b32 v53, 0xffff0000, v53
    v_max_f32 v8, v8, v53
    s_waitcnt vmcnt(16)
    s_mov_b32 s10, 77824
    buffer_load_dwordx4 a[76:79], v0, s[4:7], s10 offen nt
    s_waitcnt vmcnt(16)
    s_mov_b32 s10, 81920
    buffer_load_dwordx4 a[80:83], v0, s[4:7], s10 offen nt
    v_mov_b32 v42, 0xff800000
    v_mov_b32 v43, 0xff800000
    v_dot2_f32_bf16 v40, v232, v36, 0
    v_dot2_f32_bf16 v41, v236, v36, 0
    s_nop 1
    v_dot2c_f32_bf16 v40, v233, v37
    v_dot2c_f32_bf16 v41, v237, v37
    v_dot2c_f32_bf16 v40, v234, v38
    v_dot2c_f32_bf16 v41, v238, v38
    v_dot2c_f32_bf16 v40, v235, v39
    v_dot2c_f32_bf16 v41, v239, v39
    s_nop 1
    v_add_f32_dpp v40, v40, v40 row_ror:8 row_mask:0xf bank_mask:0x3
    v_add_f32_dpp v41, v41, v41 row_ror:8 row_mask:0xf bank_mask:0x3
    s_nop 0
    v_add_f32_dpp v40, v42, v42 row_ror:8 row_mask:0xf bank_mask:0xc
    v_add_f32_dpp v41, v43, v43 row_ror:8 row_mask:0xf bank_mask:0xc
    s_nop 0
    v_add_f32_dpp v54, v40, v40 row_shl:4 row_mask:0xf bank_mask:0x5
    s_nop 1
    v_add_f32_dpp v54, v41, v41 row_shr:4 row_mask:0xf bank_mask:0xa
    s_nop 1
    v_add_f32_dpp v54, v54, v54 quad_perm:[1,0,3,2] row_mask:0xf bank_mask:0xf
    s_nop 1
    v_add_f32_dpp v54, v54, v54 quad_perm:[2,3,0,1] row_mask:0xf bank_mask:0xf
    v_cvt_pk_bf16_f32 v54, v54, v54
    v_and_b32 v54, 0xffff0000, v54
    v_mul_f32 v54, 0x3db504f3, v54
    v_cvt_pk_bf16_f32 v54, v54, v54
    v_and_b32 v54, 0xffff0000, v54
    v_max_f32 v8, v8, v54
    s_nop 1
    v_max_f32_dpp v8, v8, v8 row_ror:4 row_mask:0xf bank_mask:0xf
    s_nop 1
    v_max_f32_dpp v8, v8, v8 row_ror:8 row_mask:0xf bank_mask:0xf
    v_mov_b32 v7, v8
    s_nop 1
    v_permlane16_swap_b32 v7, v8
    v_max_f32 v8, v8, v7
    v_mov_b32 v7, v8
    s_nop 1
    v_permlane32_swap_b32 v7, v8
    v_max_f32 v8, v8, v7
    v_mul_f32 v8, s67, v8
    v_fma_f32 v44, v44, s67, -v8
    v_fma_f32 v45, v45, s67, -v8
    v_fma_f32 v46, v46, s67, -v8
    v_fma_f32 v47, v47, s67, -v8
    v_fma_f32 v48, v48, s67, -v8
    v_fma_f32 v49, v49, s67, -v8
    v_fma_f32 v50, v50, s67, -v8
    v_fma_f32 v51, v51, s67, -v8
    v_fma_f32 v52, v52, s67, -v8
    v_fma_f32 v53, v53, s67, -v8
    v_fma_f32 v54, v54, s67, -v8
    v_exp_f32 v44, v44
    v_exp_f32 v45, v45
    v_exp_f32 v46, v46
    v_exp_f32 v47, v47
    v_exp_f32 v48, v48
    v_exp_f32 v49, v49
    v_exp_f32 v50, v50
    v_exp_f32 v51, v51
    v_exp_f32 v52, v52
    v_exp_f32 v53, v53
    v_exp_f32 v54, v54
    v_add_f32 v5, v44, v45
    v_add_f32 v5, v5, v46
    v_add_f32 v5, v5, v47
    v_add_f32 v5, v5, v48
    v_add_f32 v5, v5, v49
    v_add_f32 v5, v5, v50
    v_add_f32 v5, v5, v51
    v_add_f32 v5, v5, v52
    v_add_f32 v5, v5, v53
    v_add_f32 v5, v5, v54
    v_cvt_pk_bf16_f32 v44, v44, v44
    v_cvt_pk_bf16_f32 v45, v45, v45
    v_cvt_pk_bf16_f32 v46, v46, v46
    v_cvt_pk_bf16_f32 v47, v47, v47
    v_cvt_pk_bf16_f32 v48, v48, v48
    v_cvt_pk_bf16_f32 v49, v49, v49
    v_cvt_pk_bf16_f32 v50, v50, v50
    v_cvt_pk_bf16_f32 v51, v51, v51
    v_cvt_pk_bf16_f32 v52, v52, v52
    v_cvt_pk_bf16_f32 v53, v53, v53
    v_cvt_pk_bf16_f32 v54, v54, v54
    v_add_f32_dpp v5, v5, v5 row_ror:4 row_mask:0xf bank_mask:0xf
    s_nop 1
    v_add_f32_dpp v5, v5, v5 row_ror:8 row_mask:0xf bank_mask:0xf
    v_mov_b32 v7, v5
    s_nop 1
    v_permlane16_swap_b32 v7, v5
    v_add_f32 v5, v5, v7
    v_mov_b32 v7, v5
    s_nop 1
    v_permlane32_swap_b32 v7, v5
    v_add_f32 v5, v5, v7
    s_lshl_b32 s3, s56, 2
    s_add_u32 s3, s3, 13440
    v_mov_b32 v7, s3
    ds_write2_b32 v7, v8, v5 offset0:0 offset1:4
    s_lshl_b32 s62, s57, 1
    s_add_u32 s62, s62, s58
    s_mul_i32 s62, s62, 3
    s_add_u32 s62, s62, s59
    s_lshl_b32 s62, s62, 10
    s_add_u32 s68, s62, 524288
    v_mov_b32 v37, 0
    v_mov_b32 v4, 0
    v_mov_b32 v5, 1
    s_mov_b64 exec, 1
    ds_add_rtn_u32 v5, v4, v5 offset:13324
    s_mov_b64 exec, -1
    s_waitcnt lgkmcnt(0)
    v_readfirstlane_b32 s3, v5
    s_cmp_lg_u32 s3, 3
    s_cbranch_scc1 L_nostat_25
    ds_read_b128 v[56:59], v37 offset:13440
    ds_read_b128 v[60:63], v37 offset:13456
    v_mov_b32 v6, s60
    v_mov_b32 v7, s60
    s_waitcnt lgkmcnt(0)
    v_max3_f32 v4, v56, v57, v58
    v_max_f32 v4, v4, v59
    v_sub_f32 v56, v56, v4
    v_sub_f32 v57, v57, v4
    v_sub_f32 v58, v58, v4
    v_sub_f32 v59, v59, v4
    v_exp_f32 v56, v56
    v_exp_f32 v57, v57
    v_exp_f32 v58, v58
    v_exp_f32 v59, v59
    v_mul_f32 v5, v60, v56
    v_fmac_f32 v5, v61, v57
    v_fmac_f32 v5, v62, v58
    v_fmac_f32 v5, v63, v59
    ds_write_b128 v37, v[56:59] offset:13472
    s_mov_b64 exec, 1
    s_cmp_eq_u32 s0, 0
    s_cbranch_scc1 L_far_26
    buffer_store_dwordx4 v[4:7], v37, s[48:51], s68 offen offset:512
    s_branch L_join_27
L_far_26:
    buffer_store_dwordx4 v[4:7], v37, s[48:51], s68 offen offset:512 sc1
L_join_27:
    s_nop 1
    s_mov_b64 exec, -1
L_nostat_25:
    s_mov_b32 s36, s30
    s_and_b32 s37, s31, 0xffff
    s_mov_b32 s38, 4096
    s_mov_b32 s39, 0x20000
    v_cmp_gt_u32 vcc, 8, v2
    s_nop 1
    v_cndmask_b32 v112, v15, v14, vcc
    v_cndmask_b32 v113, v17, v16, vcc
    v_cndmask_b32 v114, v19, v18, vcc
    v_cndmask_b32 v115, v21, v20, vcc
    v_cmp_eq_u32 s[40:41], 15, v2
    v_and_b32 v4, 3, v2
    v_cmp_eq_u32 s[42:43], 0, v4
    v_mov_b32 v92, 0x7fff0000
    v_cndmask_b32 v91, 0, 1.0, s[40:41]
    v_lshlrev_b32 v90, 7, v3
    v_lshl_add_u32 v90, v2, 2, v90
    s_mul_i32 s3, s70, 2560
    v_add_u32 v90, s3, v90
    v_and_b32 v4, 1, v3
    v_lshlrev_b32 v4, 3, v4
    v_lshrrev_b32 v94, 1, v3
    v_lshl_add_u32 v4, v94, 11, v4
    s_lshl_b32 s3, s70, 8
    v_add_u32 v4, s3, v4
    v_lshl_add_u32 v94, v2, 4, v4
    v_cndmask_b32 v88, v94, v92, s[40:41]
    v_lshrrev_b32 v94, 1, v2
    v_add_u32 v94, v94, v4
    v_add_u32 v94, 240, v94
    v_cndmask_b32 v89, v92, v94, s[42:43]
    s_mul_i32 s62, s57, 6144
    s_add_u32 s62, s62, 524288
    s_add_u32 s63, s62, 3072
    v_min_u32 v5, 2, v3
    v_lshlrev_b32 v5, 10, v5
    v_lshrrev_b32 v6, 3, v2
    v_mul_u32_u24 v6, 3072, v6
    v_add_u32 v86, v6, v5
    v_lshl_add_u32 v5, v2, 4, v5
    s_lshl_b32 s3, s71, 8
    v_add_u32 v87, s3, v5
    v_mov_b32 v38, 14336
    v_and_b32 v4, 1, v3
    v_lshlrev_b32 v5, 5, v2
    v_lshl_add_u32 v5, v4, 4, v5
    s_lshl_b32 s3, s56, 9
    v_add_u32 v5, s3, v5
    v_mov_b32 v36, v5
    v_mov_b32 v8, 1
    v_and_b32_dpp v24, v44, v10 row_newbcast:0 row_mask:0xf bank_mask:0xf
    v_and_b32_dpp v25, v44, v11 row_newbcast:0 row_mask:0xf bank_mask:0xf
    v_and_b32_dpp v26, v44, v12 row_newbcast:0 row_mask:0xf bank_mask:0xf
    v_and_b32_dpp v27, v44, v13 row_newbcast:0 row_mask:0xf bank_mask:0xf
    v_and_b32_dpp v28, v44, v10 row_newbcast:4 row_mask:0xf bank_mask:0xf
    v_and_b32_dpp v29, v44, v11 row_newbcast:4 row_mask:0xf bank_mask:0xf
    v_and_b32_dpp v30, v44, v12 row_newbcast:4 row_mask:0xf bank_mask:0xf
    v_and_b32_dpp v31, v44, v13 row_newbcast:4 row_mask:0xf bank_mask:0xf
    s_mov_b32 s10, 86016
    buffer_load_dwordx4 a[84:87], v0, s[4:7], s10 offen nt
    v_and_b32_dpp v120, v46, v10 row_newbcast:0 row_mask:0xf bank_mask:0xf
    v_and_b32_dpp v121, v46, v11 row_newbcast:0 row_mask:0xf bank_mask:0xf
    v_and_b32_dpp v122, v46, v12 row_newbcast:0 row_mask:0xf bank_mask:0xf
    v_and_b32_dpp v123, v46, v13 row_newbcast:0 row_mask:0xf bank_mask:0xf
    v_and_b32_dpp v124, v46, v10 row_newbcast:4 row_mask:0xf bank_mask:0xf
    v_and_b32_dpp v125, v46, v11 row_newbcast:4 row_mask:0xf bank_mask:0xf
    v_and_b32_dpp v126, v46, v12 row_newbcast:4 row_mask:0xf bank_mask:0xf
    v_and_b32_dpp v127, v46, v13 row_newbcast:4 row_mask:0xf bank_mask:0xf
    s_mov_b32 s10, 90112
    buffer_load_dwordx4 a[88:91], v0, s[4:7], s10 offen nt
    v_and_b32_dpp v128, v46, v10 row_newbcast:8 row_mask:0xf bank_mask:0xf
    v_and_b32_dpp v129, v46, v11 row_newbcast:8 row_mask:0xf bank_mask:0xf
    v_and_b32_dpp v130, v46, v12 row_newbcast:8 row_mask:0xf bank_mask:0xf
    v_and_b32_dpp v131, v46, v13 row_newbcast:8 row_mask:0xf bank_mask:0xf
    v_and_b32_dpp v132, v46, v10 row_newbcast:12 row_mask:0xf bank_mask:0xf
    v_and_b32_dpp v133, v46, v11 row_newbcast:12 row_mask:0xf bank_mask:0xf
    v_and_b32_dpp v134, v46, v12 row_newbcast:12 row_mask:0xf bank_mask:0xf
    v_and_b32_dpp v135, v46, v13 row_newbcast:12 row_mask:0xf bank_mask:0xf
    s_mov_b32 s10, 94208
    buffer_load_dwordx4 a[92:95], v0, s[4:7], s10 offen nt
    v_and_b32_dpp v136, v47, v10 row_newbcast:0 row_mask:0xf bank_mask:0xf
    v_and_b32_dpp v137, v47, v11 row_newbcast:0 row_mask:0xf bank_mask:0xf
    v_and_b32_dpp v138, v47, v12 row_newbcast:0 row_mask:0xf bank_mask:0xf
    v_and_b32_dpp v139, v47, v13 row_newbcast:0 row_mask:0xf bank_mask:0xf
    v_and_b32_dpp v140, v47, v10 row_newbcast:4 row_mask:0xf bank_mask:0xf
    v_and_b32_dpp v141, v47, v11 row_newbcast:4 row_mask:0xf bank_mask:0xf
    v_and_b32_dpp v142, v47, v12 row_newbcast:4 row_mask:0xf bank_mask:0xf
    v_and_b32_dpp v143, v47, v13 row_newbcast:4 row_mask:0xf bank_mask:0xf
    s_mov_b32 s10, 98304
    buffer_load_dwordx4 a[96:99], v0, s[4:7], s10 offen nt
    v_and_b32_dpp v144, v47, v10 row_newbcast:8 row_mask:0xf bank_mask:0xf
    v_and_b32_dpp v145, v47, v11 row_newbcast:8 row_mask:0xf bank_mask:0xf
    v_and_b32_dpp v146, v47, v12 row_newbcast:8 row_mask:0xf bank_mask:0xf
    v_and_b32_dpp v147, v47, v13 row_newbcast:8 row_mask:0xf bank_mask:0xf
    v_and_b32_dpp v148, v47, v10 row_newbcast:12 row_mask:0xf bank_mask:0xf
    v_and_b32_dpp v149, v47, v11 row_newbcast:12 row_mask:0xf bank_mask:0xf
    v_and_b32_dpp v150, v47, v12 row_newbcast:12 row_mask:0xf bank_mask:0xf
    v_and_b32_dpp v151, v47, v13 row_newbcast:12 row_mask:0xf bank_mask:0xf
    s_mov_b32 s10, 102400
    buffer_load_dwordx4 a[100:103], v0, s[4:7], s10 offen nt
    v_and_b32_dpp v152, v48, v10 row_newbcast:0 row_mask:0xf bank_mask:0xf
    v_and_b32_dpp v153, v48, v11 row_newbcast:0 row_mask:0xf bank_mask:0xf
    v_and_b32_dpp v154, v48, v12 row_newbcast:0 row_mask:0xf bank_mask:0xf
    v_and_b32_dpp v155, v48, v13 row_newbcast:0 row_mask:0xf bank_mask:0xf
    v_and_b32_dpp v156, v48, v10 row_newbcast:4 row_mask:0xf bank_mask:0xf
    v_and_b32_dpp v157, v48, v11 row_newbcast:4 row_mask:0xf bank_mask:0xf
    v_and_b32_dpp v158, v48, v12 row_newbcast:4 row_mask:0xf bank_mask:0xf
    v_and_b32_dpp v159, v48, v13 row_newbcast:4 row_mask:0xf bank_mask:0xf
    s_mov_b32 s10, 106496
    buffer_load_dwordx4 a[104:107], v0, s[4:7], s10 offen nt
    v_and_b32_dpp v160, v48, v10 row_newbcast:8 row_mask:0xf bank_mask:0xf
    v_and_b32_dpp v161, v48, v11 row_newbcast:8 row_mask:0xf bank_mask:0xf
    v_and_b32_dpp v162, v48, v12 row_newbcast:8 row_mask:0xf bank_mask:0xf
    v_and_b32_dpp v163, v48, v13 row_newbcast:8 row_mask:0xf bank_mask:0xf
    v_and_b32_dpp v164, v48, v10 row_newbcast:12 row_mask:0xf bank_mask:0xf
    v_and_b32_dpp v165, v48, v11 row_newbcast:12 row_mask:0xf bank_mask:0xf
    v_and_b32_dpp v166, v48, v12 row_newbcast:12 row_mask:0xf bank_mask:0xf
    v_and_b32_dpp v167, v48, v13 row_newbcast:12 row_mask:0xf bank_mask:0xf
    s_mov_b32 s10, 110592
    buffer_load_dwordx4 a[108:111], v0, s[4:7], s10 offen nt
    v_and_b32_dpp v168, v49, v10 row_newbcast:0 row_mask:0xf bank_mask:0xf
    v_and_b32_dpp v169, v49, v11 row_newbcast:0 row_mask:0xf bank_mask:0xf
    v_and_b32_dpp v170, v49, v12 row_newbcast:0 row_mask:0xf bank_mask:0xf
    v_and_b32_dpp v171, v49, v13 row_newbcast:0 row_mask:0xf bank_mask:0xf
    v_and_b32_dpp v172, v49, v10 row_newbcast:4 row_mask:0xf bank_mask:0xf
    v_and_b32_dpp v173, v49, v11 row_newbcast:4 row_mask:0xf bank_mask:0xf
    v_and_b32_dpp v174, v49, v12 row_newbcast:4 row_mask:0xf bank_mask:0xf
    v_and_b32_dpp v175, v49, v13 row_newbcast:4 row_mask:0xf bank_mask:0xf
    s_mov_b32 s10, 114688
    buffer_load_dwordx4 a[112:115], v0, s[4:7], s10 offen nt
    v_and_b32_dpp v176, v49, v10 row_newbcast:8 row_mask:0xf bank_mask:0xf
    v_and_b32_dpp v177, v49, v11 row_newbcast:8 row_mask:0xf bank_mask:0xf
    v_and_b32_dpp v178, v49, v12 row_newbcast:8 row_mask:0xf bank_mask:0xf
    v_and_b32_dpp v179, v49, v13 row_newbcast:8 row_mask:0xf bank_mask:0xf
    v_and_b32_dpp v180, v49, v10 row_newbcast:12 row_mask:0xf bank_mask:0xf
    v_and_b32_dpp v181, v49, v11 row_newbcast:12 row_mask:0xf bank_mask:0xf
    v_and_b32_dpp v182, v49, v12 row_newbcast:12 row_mask:0xf bank_mask:0xf
    v_and_b32_dpp v183, v49, v13 row_newbcast:12 row_mask:0xf bank_mask:0xf
    s_mov_b32 s10, 118784
    buffer_load_dwordx4 a[116:119], v0, s[4:7], s10 offen nt
    v_and_b32_dpp v184, v50, v10 row_newbcast:0 row_mask:0xf bank_mask:0xf
    v_and_b32_dpp v185, v50, v11 row_newbcast:0 row_mask:0xf bank_mask:0xf
    v_and_b32_dpp v186, v50, v12 row_newbcast:0 row_mask:0xf bank_mask:0xf
    v_and_b32_dpp v187, v50, v13 row_newbcast:0 row_mask:0xf bank_mask:0xf
    v_and_b32_dpp v188, v50, v10 row_newbcast:4 row_mask:0xf bank_mask:0xf
    v_and_b32_dpp v189, v50, v11 row_newbcast:4 row_mask:0xf bank_mask:0xf
    v_and_b32_dpp v190, v50, v12 row_newbcast:4 row_mask:0xf bank_mask:0xf
    v_and_b32_dpp v191, v50, v13 row_newbcast:4 row_mask:0xf bank_mask:0xf
    s_mov_b32 s10, 122880
    buffer_load_dwordx4 a[120:123], v0, s[4:7], s10 offen nt
    v_and_b32_dpp v192, v50, v10 row_newbcast:8 row_mask:0xf bank_mask:0xf
    v_and_b32_dpp v193, v50, v11 row_newbcast:8 row_mask:0xf bank_mask:0xf
    v_and_b32_dpp v194, v50, v12 row_newbcast:8 row_mask:0xf bank_mask:0xf
    v_and_b32_dpp v195, v50, v13 row_newbcast:8 row_mask:0xf bank_mask:0xf
    v_and_b32_dpp v196, v50, v10 row_newbcast:12 row_mask:0xf bank_mask:0xf
    v_and_b32_dpp v197, v50, v11 row_newbcast:12 row_mask:0xf bank_mask:0xf
    v_and_b32_dpp v198, v50, v12 row_newbcast:12 row_mask:0xf bank_mask:0xf
    v_and_b32_dpp v199, v50, v13 row_newbcast:12 row_mask:0xf bank_mask:0xf
    s_mov_b32 s10, 126976
    buffer_load_dwordx4 a[124:127], v0, s[4:7], s10 offen nt
    v_and_b32_dpp v200, v51, v10 row_newbcast:0 row_mask:0xf bank_mask:0xf
    v_and_b32_dpp v201, v51, v11 row_newbcast:0 row_mask:0xf bank_mask:0xf
    v_and_b32_dpp v202, v51, v12 row_newbcast:0 row_mask:0xf bank_mask:0xf
    v_and_b32_dpp v203, v51, v13 row_newbcast:0 row_mask:0xf bank_mask:0xf
    v_and_b32_dpp v204, v51, v10 row_newbcast:4 row_mask:0xf bank_mask:0xf
    v_and_b32_dpp v205, v51, v11 row_newbcast:4 row_mask:0xf bank_mask:0xf
    v_and_b32_dpp v206, v51, v12 row_newbcast:4 row_mask:0xf bank_mask:0xf
    v_and_b32_dpp v207, v51, v13 row_newbcast:4 row_mask:0xf bank_mask:0xf
    s_mov_b32 s10, 131072
    buffer_load_dwordx4 a[128:131], v0, s[4:7], s10 offen nt
    v_and_b32_dpp v208, v51, v10 row_newbcast:8 row_mask:0xf bank_mask:0xf
    v_and_b32_dpp v209, v51, v11 row_newbcast:8 row_mask:0xf bank_mask:0xf
    v_and_b32_dpp v210, v51, v12 row_newbcast:8 row_mask:0xf bank_mask:0xf
    v_and_b32_dpp v211, v51, v13 row_newbcast:8 row_mask:0xf bank_mask:0xf
    v_and_b32_dpp v212, v51, v10 row_newbcast:12 row_mask:0xf bank_mask:0xf
    v_and_b32_dpp v213, v51, v11 row_newbcast:12 row_mask:0xf bank_mask:0xf
    v_and_b32_dpp v214, v51, v12 row_newbcast:12 row_mask:0xf bank_mask:0xf
    v_and_b32_dpp v215, v51, v13 row_newbcast:12 row_mask:0xf bank_mask:0xf
    s_mov_b32 s10, 135168
    buffer_load_dwordx4 a[132:135], v0, s[4:7], s10 offen nt
    v_and_b32_dpp v216, v52, v10 row_newbcast:0 row_mask:0xf bank_mask:0xf
    v_and_b32_dpp v217, v52, v11 row_newbcast:0 row_mask:0xf bank_mask:0xf
    v_and_b32_dpp v218, v52, v12 row_newbcast:0 row_mask:0xf bank_mask:0xf
    v_and_b32_dpp v219, v52, v13 row_newbcast:0 row_mask:0xf bank_mask:0xf
    v_and_b32_dpp v220, v52, v10 row_newbcast:4 row_mask:0xf bank_mask:0xf
    v_and_b32_dpp v221, v52, v11 row_newbcast:4 row_mask:0xf bank_mask:0xf
    v_and_b32_dpp v222, v52, v12 row_newbcast:4 row_mask:0xf bank_mask:0xf
    v_and_b32_dpp v223, v52, v13 row_newbcast:4 row_mask:0xf bank_mask:0xf
    s_mov_b32 s10, 139264
    buffer_load_dwordx4 a[136:139], v0, s[4:7], s10 offen nt
    v_and_b32_dpp v224, v52, v10 row_newbcast:8 row_mask:0xf bank_mask:0xf
    v_and_b32_dpp v225, v52, v11 row_newbcast:8 row_mask:0xf bank_mask:0xf
    v_and_b32_dpp v226, v52, v12 row_newbcast:8 row_mask:0xf bank_mask:0xf
    v_and_b32_dpp v227, v52, v13 row_newbcast:8 row_mask:0xf bank_mask:0xf
    v_and_b32_dpp v228, v52, v10 row_newbcast:12 row_mask:0xf bank_mask:0xf
    v_and_b32_dpp v229, v52, v11 row_newbcast:12 row_mask:0xf bank_mask:0xf
    v_and_b32_dpp v230, v52, v12 row_newbcast:12 row_mask:0xf bank_mask:0xf
    v_and_b32_dpp v231, v52, v13 row_newbcast:12 row_mask:0xf bank_mask:0xf
    s_mov_b32 s10, 143360
    buffer_load_dwordx4 a[140:143], v0, s[4:7], s10 offen nt
    v_and_b32_dpp v232, v53, v10 row_newbcast:0 row_mask:0xf bank_mask:0xf
    v_and_b32_dpp v233, v53, v11 row_newbcast:0 row_mask:0xf bank_mask:0xf
    v_and_b32_dpp v234, v53, v12 row_newbcast:0 row_mask:0xf bank_mask:0xf
    v_and_b32_dpp v235, v53, v13 row_newbcast:0 row_mask:0xf bank_mask:0xf
    v_and_b32_dpp v236, v53, v10 row_newbcast:4 row_mask:0xf bank_mask:0xf
    v_and_b32_dpp v237, v53, v11 row_newbcast:4 row_mask:0xf bank_mask:0xf
    v_and_b32_dpp v238, v53, v12 row_newbcast:4 row_mask:0xf bank_mask:0xf
    v_and_b32_dpp v239, v53, v13 row_newbcast:4 row_mask:0xf bank_mask:0xf
    s_mov_b32 s10, 147456
    buffer_load_dwordx4 a[144:147], v0, s[4:7], s10 offen nt
    v_and_b32_dpp v240, v53, v10 row_newbcast:8 row_mask:0xf bank_mask:0xf
    v_and_b32_dpp v241, v53, v11 row_newbcast:8 row_mask:0xf bank_mask:0xf
    v_and_b32_dpp v242, v53, v12 row_newbcast:8 row_mask:0xf bank_mask:0xf
    v_and_b32_dpp v243, v53, v13 row_newbcast:8 row_mask:0xf bank_mask:0xf
    v_and_b32_dpp v244, v53, v10 row_newbcast:12 row_mask:0xf bank_mask:0xf
    v_and_b32_dpp v245, v53, v11 row_newbcast:12 row_mask:0xf bank_mask:0xf
    v_and_b32_dpp v246, v53, v12 row_newbcast:12 row_mask:0xf bank_mask:0xf
    v_and_b32_dpp v247, v53, v13 row_newbcast:12 row_mask:0xf bank_mask:0xf
    s_mov_b32 s10, 151552
    buffer_load_dwordx4 a[148:151], v0, s[4:7], s10 offen nt
    v_and_b32_dpp v248, v54, v10 row_newbcast:0 row_mask:0xf bank_mask:0xf
    v_and_b32_dpp v249, v54, v11 row_newbcast:0 row_mask:0xf bank_mask:0xf
    v_and_b32_dpp v250, v54, v12 row_newbcast:0 row_mask:0xf bank_mask:0xf
    v_and_b32_dpp v251, v54, v13 row_newbcast:0 row_mask:0xf bank_mask:0xf
    v_and_b32_dpp v252, v54, v10 row_newbcast:4 row_mask:0xf bank_mask:0xf
    v_and_b32_dpp v253, v54, v11 row_newbcast:4 row_mask:0xf bank_mask:0xf
    v_and_b32_dpp v254, v54, v12 row_newbcast:4 row_mask:0xf bank_mask:0xf
    v_and_b32_dpp v255, v54, v13 row_newbcast:4 row_mask:0xf bank_mask:0xf
    s_mov_b32 s10, 155648
    buffer_load_dwordx4 a[152:155], v0, s[4:7], s10 offen nt
    s_mov_b32 s10, 159744
    buffer_load_dwordx4 a[156:159], v0, s[4:7], s10 offen nt
    s_mov_b32 s10, 163840
    buffer_load_dwordx4 a[160:163], v0, s[4:7], s10 offen nt
    s_mov_b32 s10, 167936
    buffer_load_dwordx4 a[164:167], v0, s[4:7], s10 offen nt
    v_mfma_f32_16x16x32_bf16 v[32:35], v[24:27], a[0:3], 0
    v_and_b32_dpp v24, v44, v10 row_newbcast:8 row_mask:0xf bank_mask:0xf
    v_and_b32_dpp v25, v44, v11 row_newbcast:8 row_mask:0xf bank_mask:0xf
    v_and_b32_dpp v26, v44, v12 row_newbcast:8 row_mask:0xf bank_mask:0xf
    v_and_b32_dpp v27, v44, v13 row_newbcast:8 row_mask:0xf bank_mask:0xf
    v_mfma_f32_16x16x32_bf16 v[32:35], v[28:31], a[4:7], v[32:35]
    v_and_b32_dpp v28, v44, v10 row_newbcast:12 row_mask:0xf bank_mask:0xf
    v_and_b32_dpp v29, v44, v11 row_newbcast:12 row_mask:0xf bank_mask:0xf
    v_and_b32_dpp v30, v44, v12 row_newbcast:12 row_mask:0xf bank_mask:0xf
    v_and_b32_dpp v31, v44, v13 row_newbcast:12 row_mask:0xf bank_mask:0xf
    v_mfma_f32_16x16x32_bf16 v[32:35], v[24:27], a[8:11], v[32:35]
    v_and_b32_dpp v24, v45, v10 row_newbcast:0 row_mask:0xf bank_mask:0xf
    v_and_b32_dpp v25, v45, v11 row_newbcast:0 row_mask:0xf bank_mask:0xf
    v_and_b32_dpp v26, v45, v12 row_newbcast:0 row_mask:0xf bank_mask:0xf
    v_and_b32_dpp v27, v45, v13 row_newbcast:0 row_mask:0xf bank_mask:0xf
    v_mfma_f32_16x16x32_bf16 v[32:35], v[28:31], a[12:15], v[32:35]
    v_and_b32_dpp v28, v45, v10 row_newbcast:4 row_mask:0xf bank_mask:0xf
    v_and_b32_dpp v29, v45, v11 row_newbcast:4 row_mask:0xf bank_mask:0xf
    v_and_b32_dpp v30, v45, v12 row_newbcast:4 row_mask:0xf bank_mask:0xf
    v_and_b32_dpp v31, v45, v13 row_newbcast:4 row_mask:0xf bank_mask:0xf
    s_waitcnt vmcnt(34)
    v_mfma_f32_16x16x32_bf16 v[32:35], v[24:27], a[16:19], v[32:35]
    v_and_b32_dpp v24, v45, v10 row_newbcast:8 row_mask:0xf bank_mask:0xf
    v_and_b32_dpp v25, v45, v11 row_newbcast:8 row_mask:0xf bank_mask:0xf
    v_and_b32_dpp v26, v45, v12 row_newbcast:8 row_mask:0xf bank_mask:0xf
    v_and_b32_dpp v27, v45, v13 row_newbcast:8 row_mask:0xf bank_mask:0xf
    v_mfma_f32_16x16x32_bf16 v[32:35], v[28:31], a[20:23], v[32:35]
    v_and_b32_dpp v28, v45, v10 row_newbcast:12 row_mask:0xf bank_mask:0xf
    v_and_b32_dpp v29, v45, v11 row_newbcast:12 row_mask:0xf bank_mask:0xf
    v_and_b32_dpp v30, v45, v12 row_newbcast:12 row_mask:0xf bank_mask:0xf
    v_and_b32_dpp v31, v45, v13 row_newbcast:12 row_mask:0xf bank_mask:0xf
    v_mfma_f32_16x16x32_bf16 v[32:35], v[24:27], a[24:27], v[32:35]
    s_nop 0
    v_mfma_f32_16x16x32_bf16 v[32:35], v[28:31], a[28:31], v[32:35]
    s_waitcnt vmcnt(30)
    v_mfma_f32_16x16x32_bf16 v[32:35], v[120:123], a[32:35], v[32:35]
    v_mfma_f32_16x16x32_bf16 v[32:35], v[124:127], a[36:39], v[32:35]
    v_mfma_f32_16x16x32_bf16 v[32:35], v[128:131], a[40:43], v[32:35]
    v_mfma_f32_16x16x32_bf16 v[32:35], v[132:135], a[44:47], v[32:35]
    s_waitcnt vmcnt(26)
    v_mfma_f32_16x16x32_bf16 v[32:35], v[136:139], a[48:51], v[32:35]
    v_mfma_f32_16x16x32_bf16 v[32:35], v[140:143], a[52:55], v[32:35]
    v_mfma_f32_16x16x32_bf16 v[32:35], v[144:147], a[56:59], v[32:35]
    v_mfma_f32_16x16x32_bf16 v[32:35], v[148:151], a[60:63], v[32:35]
    s_waitcnt vmcnt(22)
    v_mfma_f32_16x16x32_bf16 v[32:35], v[152:155], a[64:67], v[32:35]
    v_mfma_f32_16x16x32_bf16 v[32:35], v[156:159], a[68:71], v[32:35]
    v_mfma_f32_16x16x32_bf16 v[32:35], v[160:163], a[72:75], v[32:35]
    v_mfma_f32_16x16x32_bf16 v[32:35], v[164:167], a[76:79], v[32:35]
    s_waitcnt vmcnt(18)
    v_mfma_f32_16x16x32_bf16 v[32:35], v[168:171], a[80:83], v[32:35]
    v_mfma_f32_16x16x32_bf16 v[32:35], v[172:175], a[84:87], v[32:35]
    v_mfma_f32_16x16x32_bf16 v[32:35], v[176:179], a[88:91], v[32:35]
    v_mfma_f32_16x16x32_bf16 v[32:35], v[180:183], a[92:95], v[32:35]
    s_waitcnt vmcnt(14)
    v_mfma_f32_16x16x32_bf16 v[32:35], v[184:187], a[96:99], v[32:35]
    v_mfma_f32_16x16x32_bf16 v[32:35], v[188:191], a[100:103], v[32:35]
    v_mfma_f32_16x16x32_bf16 v[32:35], v[192:195], a[104:107], v[32:35]
    v_mfma_f32_16x16x32_bf16 v[32:35], v[196:199], a[108:111], v[32:35]
    s_waitcnt vmcnt(10)
    v_mfma_f32_16x16x32_bf16 v[32:35], v[200:203], a[112:115], v[32:35]
    v_mfma_f32_16x16x32_bf16 v[32:35], v[204:207], a[116:119], v[32:35]
    v_mfma_f32_16x16x32_bf16 v[32:35], v[208:211], a[120:123], v[32:35]
    v_mfma_f32_16x16x32_bf16 v[32:35], v[212:215], a[124:127], v[32:35]
    s_waitcnt vmcnt(6)
    v_mfma_f32_16x16x32_bf16 v[32:35], v[216:219], a[128:131], v[32:35]
    v_mfma_f32_16x16x32_bf16 v[32:35], v[220:223], a[132:135], v[32:35]
    v_mfma_f32_16x16x32_bf16 v[32:35], v[224:227], a[136:139], v[32:35]
    buffer_load_dwordx4 v[80:83], v86, s[48:51], s62 offen offset:512 sc1
    buffer_load_dwordx2 v[84:85], v38, s[48:51], 0 offen sc1
    v_mfma_f32_16x16x32_bf16 v[32:35], v[228:231], a[140:143], v[32:35]
    s_mov_b32 s61, 0
    buffer_load_dwordx4 a[192:195], v23, s[44:47], s61 offen
    s_waitcnt vmcnt(8)
    v_mfma_f32_16x16x32_bf16 v[32:35], v[232:235], a[144:147], v[32:35]
    s_mov_b32 s61, 4096
    buffer_load_dwordx4 a[196:199], v23, s[44:47], s61 offen
    s_waitcnt vmcnt(8)
    v_mfma_f32_16x16x32_bf16 v[32:35], v[236:239], a[148:151], v[32:35]
    s_mov_b32 s61, 8192
    buffer_load_dwordx4 a[200:203], v23, s[44:47], s61 offen
    s_waitcnt vmcnt(8)
    v_mfma_f32_16x16x32_bf16 v[32:35], v[240:243], a[152:155], v[32:35]
    s_mov_b32 s61, 12288
    buffer_load_dwordx4 a[204:207], v23, s[44:47], s61 offen
    s_waitcnt vmcnt(8)
    v_mfma_f32_16x16x32_bf16 v[32:35], v[244:247], a[156:159], v[32:35]
    s_mov_b32 s61, 16384
    buffer_load_dwordx4 a[208:211], v23, s[44:47], s61 offen
    s_waitcnt vmcnt(8)
    v_mfma_f32_16x16x32_bf16 v[32:35], v[248:251], a[160:163], v[32:35]
    s_mov_b32 s61, 20480
    buffer_load_dwordx4 a[212:215], v23, s[44:47], s61 offen
    s_waitcnt vmcnt(8)
    v_mfma_f32_16x16x32_bf16 v[32:35], v[252:255], a[164:167], v[32:35]
    s_nop 7
    ds_write_b128 v36, v[32:35] offset:14336
    s_mov_b64 exec, 1
    ds_add_rtn_u32 v5, v37, v8 offset:13320
    s_mov_b64 exec, -1
    ds_read_b128 v[40:43], v37 offset:13472
    ds_read_b128 v[56:59], v22 offset:14336
    ds_read_b128 v[60:63], v22 offset:14848
    ds_read_b128 v[64:67], v22 offset:15360
    ds_read_b128 v[68:71], v22 offset:15872
    s_waitcnt lgkmcnt(5)
    v_readfirstlane_b32 s3, v5
    s_cmp_lg_u32 s3, 3
    s_cbranch_scc1 L_done_28
    s_mov_b32 exec_hi, 0
    s_waitcnt lgkmcnt(3)
    v_pk_mul_f32 v[32:33], v[56:57], v[40:41] op_sel:[0,0] op_sel_hi:[1,0]
    v_pk_mul_f32 v[34:35], v[58:59], v[40:41] op_sel:[0,0] op_sel_hi:[1,0]
    s_waitcnt lgkmcnt(2)
    v_pk_fma_f32 v[32:33], v[60:61], v[40:41], v[32:33] op_sel:[0,1,0] op_sel_hi:[1,1,1]
    v_pk_fma_f32 v[34:35], v[62:63], v[40:41], v[34:35] op_sel:[0,1,0] op_sel_hi:[1,1,1]
    s_waitcnt lgkmcnt(1)
    v_pk_fma_f32 v[32:33], v[64:65], v[42:43], v[32:33] op_sel:[0,0,0] op_sel_hi:[1,0,1]
    v_pk_fma_f32 v[34:35], v[66:67], v[42:43], v[34:35] op_sel:[0,0,0] op_sel_hi:[1,0,1]
    s_waitcnt lgkmcnt(0)
    v_pk_fma_f32 v[32:33], v[68:69], v[42:43], v[32:33] op_sel:[0,1,0] op_sel_hi:[1,1,1]
    v_pk_fma_f32 v[34:35], v[70:71], v[42:43], v[34:35] op_sel:[0,1,0] op_sel_hi:[1,1,1]
    v_add_u32 v32, 0x800, v32
    v_add_u32 v33, 0x800, v33
    v_add_u32 v34, 0x800, v34
    v_add_u32 v35, 0x800, v35
    v_bfi_b32 v32, s65, v9, v32
    v_bfi_b32 v33, s65, v9, v33
    v_bfi_b32 v34, s65, v9, v34
    v_bfi_b32 v35, s65, v9, v35
    s_cmp_eq_u32 s0, 0
    s_cbranch_scc1 L_far_29
    buffer_store_dwordx4 v[32:35], v22, s[48:51], s68 offen
    s_branch L_join_30
L_far_29:
    buffer_store_dwordx4 v[32:35], v22, s[48:51], s68 offen sc1
L_join_30:
    s_nop 1
    s_mov_b64 exec, -1
L_done_28:
    s_mov_b32 s61, 24576
    buffer_load_dwordx4 a[216:219], v23, s[44:47], s61 offen
    s_mov_b32 s61, 28672
    buffer_load_dwordx4 a[220:223], v23, s[44:47], s61 offen
    s_mov_b32 s61, 32768
    buffer_load_dwordx4 a[224:227], v23, s[44:47], s61 offen
    s_mov_b32 s61, 36864
    buffer_load_dwordx4 a[228:231], v23, s[44:47], s61 offen
    s_mov_b32 s61, 40960
    buffer_load_dwordx4 a[232:235], v23, s[44:47], s61 offen
    s_mov_b32 s61, 45056
    buffer_load_dwordx4 a[236:239], v23, s[44:47], s61 offen
    s_mov_b32 s61, 49152
    buffer_load_dwordx4 a[240:243], v23, s[44:47], s61 offen
    s_mov_b32 s61, 53248
    buffer_load_dwordx4 a[244:247], v23, s[44:47], s61 offen
    s_mov_b32 s61, 57344
    buffer_load_dwordx4 a[248:251], v23, s[44:47], s61 offen
    s_mov_b32 s61, 61440
    buffer_load_dwordx4 a[252:255], v23, s[44:47], s61 offen
    buffer_load_dwordx4 v[72:75], v87, s[48:51], s62 offen sc1
    buffer_load_dwordx4 v[76:79], v87, s[48:51], s63 offen sc1
    s_waitcnt vmcnt(18)
L_chk_31:
    v_xor_b32 v4, s60, v82
    v_bitop3_b32 v4, v4, v83, s60 bitop3:0xf6
    v_bitop3_b32 v4, v4, v84, s60 bitop3:0xf6
    v_bitop3_b32 v4, v4, v85, s60 bitop3:0xf6
    v_cmp_ne_u32 vcc, 0, v4
    s_cbranch_vccz L_ok_32
    s_cmp_eq_u32 s64, 0
    s_cbranch_scc1 L_ok_32
    s_sub_u32 s64, s64, 1
    buffer_load_dwordx4 v[80:83], v86, s[48:51], s62 offen offset:512 sc1
    buffer_load_dwordx2 v[84:85], v38, s[48:51], 0 offen sc1
    s_waitcnt vmcnt(0)
    s_branch L_chk_31
L_ok_32:
    v_mov_b32 v5, v80
    v_mov_b32 v7, v5
    s_nop 1
    v_permlane16_swap_b32 v7, v5
    v_max_f32 v5, v5, v7
    v_mov_b32 v7, v5
    s_nop 1
    v_permlane32_swap_b32 v7, v5
    v_max_f32 v5, v5, v7
    v_sub_f32 v5, v80, v5
    v_exp_f32 v5, v5
    v_cmp_gt_u32 vcc, 3, v3
    s_nop 1
    v_cndmask_b32 v6, 0, v5, vcc
    v_mul_f32 v5, v6, v81
    v_mov_b32 v7, v5
    s_nop 1
    v_permlane16_swap_b32 v7, v5
    v_add_f32 v5, v5, v7
    v_mov_b32 v7, v5
    s_nop 1
    v_permlane32_swap_b32 v7, v5
    v_add_f32 v5, v5, v7
    v_rcp_f32 v5, v5
    s_nop 0
    v_mul_f32 v5, v5, v6
    s_nop 1
    v_mov_b32_dpp v6, v5 row_newbcast:0 row_mask:0xf bank_mask:0xf
    v_mov_b32_dpp v7, v5 row_newbcast:8 row_mask:0xf bank_mask:0xf
L_pp_33:
    buffer_load_dwordx4 v[128:131], v87, s[48:51], s62 offen sc1
    buffer_load_dwordx4 v[132:135], v87, s[48:51], s63 offen sc1
    s_waitcnt vmcnt(2)
    v_xor_b32 v4, s60, v72
    v_bitop3_b32 v4, v4, v73, s60 bitop3:0xf6
    v_bitop3_b32 v4, v4, v74, s60 bitop3:0xf6
    v_bitop3_b32 v4, v4, v75, s60 bitop3:0xf6
    v_bitop3_b32 v4, v4, v76, s60 bitop3:0xf6
    v_bitop3_b32 v4, v4, v77, s60 bitop3:0xf6
    v_bitop3_b32 v4, v4, v78, s60 bitop3:0xf6
    v_bitop3_b32 v4, v4, v79, s60 bitop3:0xf6
    v_and_b32 v4, s65, v4
    v_cmp_ne_u32 vcc, 0, v4
    s_cbranch_vccz L_g0_34
    buffer_load_dwordx4 v[72:75], v87, s[48:51], s62 offen sc1
    buffer_load_dwordx4 v[76:79], v87, s[48:51], s63 offen sc1
    s_waitcnt vmcnt(2)
    v_xor_b32 v4, s60, v128
    v_bitop3_b32 v4, v4, v129, s60 bitop3:0xf6
    v_bitop3_b32 v4, v4, v130, s60 bitop3:0xf6
    v_bitop3_b32 v4, v4, v131, s60 bitop3:0xf6
    v_bitop3_b32 v4, v4, v132, s60 bitop3:0xf6
    v_bitop3_b32 v4, v4, v133, s60 bitop3:0xf6
    v_bitop3_b32 v4, v4, v134, s60 bitop3:0xf6
    v_bitop3_b32 v4, v4, v135, s60 bitop3:0xf6
    v_and_b32 v4, s65, v4
    v_cmp_ne_u32 vcc, 0, v4
    s_cbranch_vccz L_g1_35
    s_cmp_eq_u32 s64, 0
    s_cbranch_scc1 L_g1_35
    s_sub_u32 s64, s64, 1
    s_branch L_pp_33
L_g0_34:
    v_and_b32 v184, s66, v72
    v_and_b32 v185, s66, v73
    v_and_b32 v186, s66, v74
    v_and_b32 v187, s66, v75
    v_and_b32 v188, s66, v76
    v_and_b32 v189, s66, v77
    v_and_b32 v190, s66, v78
    v_and_b32 v191, s66, v79
    s_branch L_po_36
L_g1_35:
    v_and_b32 v184, s66, v128
    v_and_b32 v185, s66, v129
    v_and_b32 v186, s66, v130
    v_and_b32 v187, s66, v131
    v_and_b32 v188, s66, v132
    v_and_b32 v189, s66, v133
    v_and_b32 v190, s66, v134
    v_and_b32 v191, s66, v135
L_po_36:
    v_pk_mul_f32 v[184:185], v[184:185], v[6:7] op_sel:[0,0] op_sel_hi:[1,0]
    v_pk_mul_f32 v[186:187], v[186:187], v[6:7] op_sel:[0,0] op_sel_hi:[1,0]
    v_pk_mul_f32 v[188:189], v[188:189], v[6:7] op_sel:[0,1] op_sel_hi:[1,1]
    v_pk_mul_f32 v[190:191], v[190:191], v[6:7] op_sel:[0,1] op_sel_hi:[1,1]
    v_permlane16_swap_b32 v184, v185
    v_permlane16_swap_b32 v186, v187
    v_permlane16_swap_b32 v188, v189
    v_permlane16_swap_b32 v190, v191
    v_add_f32 v184, v184, v185
    v_add_f32 v186, v186, v187
    v_add_f32 v188, v188, v189
    v_add_f32 v190, v190, v191
    v_permlane32_swap_b32 v184, v186
    s_nop 0
    v_permlane32_swap_b32 v188, v190
    v_add_f32 v184, v184, v186
    v_add_f32 v188, v188, v190
    v_cvt_pk_bf16_f32 v184, v184, v188
    s_nop 1
    v_mov_b32_dpp v94, v184 row_newbcast:0 row_mask:0xf bank_mask:0xf
    v_perm_b32 v24, v94, v94, v112
    v_perm_b32 v25, v94, v94, v113
    v_perm_b32 v26, v94, v94, v114
    v_perm_b32 v27, v94, v94, v115
    v_mov_b32_dpp v95, v184 row_newbcast:1 row_mask:0xf bank_mask:0xf
    v_perm_b32 v28, v95, v95, v112
    v_perm_b32 v29, v95, v95, v113
    v_perm_b32 v30, v95, v95, v114
    v_perm_b32 v31, v95, v95, v115
    v_mfma_f32_16x16x32_bf16 v[32:35], v[24:27], a[192:195], 0
    v_mov_b32_dpp v94, v184 row_newbcast:2 row_mask:0xf bank_mask:0xf
    v_perm_b32 v24, v94, v94, v112
    v_perm_b32 v25, v94, v94, v113
    v_perm_b32 v26, v94, v94, v114
    v_perm_b32 v27, v94, v94, v115
    v_mfma_f32_16x16x32_bf16 v[32:35], v[28:31], a[196:199], v[32:35]
    v_mov_b32_dpp v95, v184 row_newbcast:3 row_mask:0xf bank_mask:0xf
    v_perm_b32 v28, v95, v95, v112
    v_perm_b32 v29, v95, v95, v113
    v_perm_b32 v30, v95, v95, v114
    v_perm_b32 v31, v95, v95, v115
    v_mfma_f32_16x16x32_bf16 v[32:35], v[24:27], a[200:203], v[32:35]
    v_mov_b32_dpp v94, v184 row_newbcast:4 row_mask:0xf bank_mask:0xf
    v_perm_b32 v24, v94, v94, v112
    v_perm_b32 v25, v94, v94, v113
    v_perm_b32 v26, v94, v94, v114
    v_perm_b32 v27, v94, v94, v115
    v_mfma_f32_16x16x32_bf16 v[32:35], v[28:31], a[204:207], v[32:35]
    v_mov_b32_dpp v95, v184 row_newbcast:5 row_mask:0xf bank_mask:0xf
    v_perm_b32 v28, v95, v95, v112
    v_perm_b32 v29, v95, v95, v113
    v_perm_b32 v30, v95, v95, v114
    v_perm_b32 v31, v95, v95, v115
    v_mfma_f32_16x16x32_bf16 v[32:35], v[24:27], a[208:211], v[32:35]
    v_mov_b32_dpp v94, v184 row_newbcast:6 row_mask:0xf bank_mask:0xf
    v_perm_b32 v24, v94, v94, v112
    v_perm_b32 v25, v94, v94, v113
    v_perm_b32 v26, v94, v94, v114
    v_perm_b32 v27, v94, v94, v115
    v_mfma_f32_16x16x32_bf16 v[32:35], v[28:31], a[212:215], v[32:35]
    v_mov_b32_dpp v95, v184 row_newbcast:7 row_mask:0xf bank_mask:0xf
    v_perm_b32 v28, v95, v95, v112
    v_perm_b32 v29, v95, v95, v113
    v_perm_b32 v30, v95, v95, v114
    v_perm_b32 v31, v95, v95, v115
    v_mfma_f32_16x16x32_bf16 v[32:35], v[24:27], a[216:219], v[32:35]
    v_mov_b32_dpp v94, v184 row_newbcast:8 row_mask:0xf bank_mask:0xf
    v_perm_b32 v24, v94, v94, v112
    v_perm_b32 v25, v94, v94, v113
    v_perm_b32 v26, v94, v94, v114
    v_perm_b32 v27, v94, v94, v115
    v_mfma_f32_16x16x32_bf16 v[32:35], v[28:31], a[220:223], v[32:35]
    v_mov_b32_dpp v95, v184 row_newbcast:9 row_mask:0xf bank_mask:0xf
    v_perm_b32 v28, v95, v95, v112
    v_perm_b32 v29, v95, v95, v113
    v_perm_b32 v30, v95, v95, v114
    v_perm_b32 v31, v95, v95, v115
    v_mfma_f32_16x16x32_bf16 v[32:35], v[24:27], a[224:227], v[32:35]
    v_mov_b32_dpp v94, v184 row_newbcast:10 row_mask:0xf bank_mask:0xf
    v_perm_b32 v24, v94, v94, v112
    v_perm_b32 v25, v94, v94, v113
    v_perm_b32 v26, v94, v94, v114
    v_perm_b32 v27, v94, v94, v115
    v_mfma_f32_16x16x32_bf16 v[32:35], v[28:31], a[228:231], v[32:35]
    v_mov_b32_dpp v95, v184 row_newbcast:11 row_mask:0xf bank_mask:0xf
    v_perm_b32 v28, v95, v95, v112
    v_perm_b32 v29, v95, v95, v113
    v_perm_b32 v30, v95, v95, v114
    v_perm_b32 v31, v95, v95, v115
    v_mfma_f32_16x16x32_bf16 v[32:35], v[24:27], a[232:235], v[32:35]
    v_mov_b32_dpp v94, v184 row_newbcast:12 row_mask:0xf bank_mask:0xf
    v_perm_b32 v24, v94, v94, v112
    v_perm_b32 v25, v94, v94, v113
    v_perm_b32 v26, v94, v94, v114
    v_perm_b32 v27, v94, v94, v115
    v_mfma_f32_16x16x32_bf16 v[32:35], v[28:31], a[236:239], v[32:35]
    v_mov_b32_dpp v95, v184 row_newbcast:13 row_mask:0xf bank_mask:0xf
    v_perm_b32 v28, v95, v95, v112
    v_perm_b32 v29, v95, v95, v113
    v_perm_b32 v30, v95, v95, v114
    v_perm_b32 v31, v95, v95, v115
    v_mfma_f32_16x16x32_bf16 v[32:35], v[24:27], a[240:243], v[32:35]
    v_mov_b32_dpp v94, v184 row_newbcast:14 row_mask:0xf bank_mask:0xf
    v_perm_b32 v24, v94, v94, v112
    v_perm_b32 v25, v94, v94, v113
    v_perm_b32 v26, v94, v94, v114
    v_perm_b32 v27, v94, v94, v115
    v_mfma_f32_16x16x32_bf16 v[32:35], v[28:31], a[244:247], v[32:35]
    v_mov_b32_dpp v95, v184 row_newbcast:15 row_mask:0xf bank_mask:0xf
    v_perm_b32 v28, v95, v95, v112
    v_perm_b32 v29, v95, v95, v113
    v_perm_b32 v30, v95, v95, v114
    v_perm_b32 v31, v95, v95, v115
    v_mfma_f32_16x16x32_bf16 v[32:35], v[24:27], a[248:251], v[32:35]
    s_nop 0
    v_mfma_f32_16x16x32_bf16 v[32:35], v[28:31], a[252:255], v[32:35]
    s_mov_b32 s3, 16384
    s_mov_b32 s61, 18432
    s_nop 5
    v_cndmask_b32 v96, v32, 1.0, s[40:41]
    buffer_atomic_add_f32 v96, v90, s[48:51], s3 offen offset:0 sc0 sc1
    v_cndmask_b32 v97, v33, 1.0, s[40:41]
    buffer_atomic_add_f32 v97, v90, s[48:51], s3 offen offset:512 sc0 sc1
    v_cndmask_b32 v98, v34, 1.0, s[40:41]
    buffer_atomic_add_f32 v98, v90, s[48:51], s3 offen offset:1024 sc0 sc1
    v_cndmask_b32 v99, v35, 1.0, s[40:41]
    buffer_atomic_add_f32 v99, v90, s[48:51], s3 offen offset:1536 sc0 sc1
    v_mov_b32_dpp v101, v32 row_newbcast:15 row_mask:0xf bank_mask:1
    s_nop 1
    v_mov_b32_dpp v101, v33 row_newbcast:15 row_mask:0xf bank_mask:2
    s_nop 1
    v_mov_b32_dpp v101, v34 row_newbcast:15 row_mask:0xf bank_mask:4
    s_nop 1
    v_mov_b32_dpp v101, v35 row_newbcast:15 row_mask:0xf bank_mask:8
    v_cndmask_b32 v100, v91, v101, s[42:43]
    buffer_atomic_add_f32 v100, v90, s[48:51], s61 offen sc0 sc1
    s_waitcnt vmcnt(0)
    v_mov_b32_dpp v104, v96 row_newbcast:15 row_mask:0xf bank_mask:0xf
    v_mov_b32_dpp v105, v97 row_newbcast:15 row_mask:0xf bank_mask:0xf
    v_mov_b32_dpp v106, v98 row_newbcast:15 row_mask:0xf bank_mask:0xf
    v_mov_b32_dpp v107, v99 row_newbcast:15 row_mask:0xf bank_mask:0xf
    v_mov_b32_dpp v108, v100 row_newbcast:15 row_mask:0xf bank_mask:0xf
    v_cmp_eq_f32 vcc, 0x427c0000, v104
    v_add_f32 v96, v96, v32
    v_cvt_pk_bf16_f32 v96, v96, v96
    v_cndmask_b32 v104, v92, v88, vcc
    buffer_store_short v96, v104, s[36:39], 0 offen offset:0
    v_cmp_eq_f32 vcc, 0x427c0000, v105
    v_add_f32 v97, v97, v33
    v_cvt_pk_bf16_f32 v97, v97, v97
    v_cndmask_b32 v105, v92, v88, vcc
    buffer_store_short v97, v105, s[36:39], 0 offen offset:2
    v_cmp_eq_f32 vcc, 0x427c0000, v106
    v_add_f32 v98, v98, v34
    v_cvt_pk_bf16_f32 v98, v98, v98
    v_cndmask_b32 v106, v92, v88, vcc
    buffer_store_short v98, v106, s[36:39], 0 offen offset:4
    v_cmp_eq_f32 vcc, 0x427c0000, v107
    v_add_f32 v99, v99, v35
    v_cvt_pk_bf16_f32 v99, v99, v99
    v_cndmask_b32 v107, v92, v88, vcc
    buffer_store_short v99, v107, s[36:39], 0 offen offset:6
    v_cmp_eq_f32 vcc, 0x427c0000, v108
    v_add_f32 v100, v100, v101
    v_cvt_pk_bf16_f32 v100, v100, v100
    v_cndmask_b32 v108, v92, v89, vcc
    buffer_store_short v100, v108, s[36:39], 0 offen offset:0
    s_endpgm
L_role_b:
    s_lshl_b32 s3, s56, 2
    s_lshl_b32 s62, s56, 10
    v_xor_b32 v4, s3, v1
    s_lshl_b32 s63, s56, 8
    v_xor_b32 v7, 0, v4
    v_lshl_add_u32 v36, v7, 4, s62
    v_xor_b32 v7, 1, v4
    v_lshl_add_u32 v37, v7, 4, s62
    v_xor_b32 v7, 2, v4
    v_lshl_add_u32 v38, v7, 4, s62
    v_xor_b32 v7, 3, v4
    v_lshl_add_u32 v39, v7, 4, s62
    s_lshl_b32 s3, s69, 18
    s_add_u32 s36, s20, s3
    s_addc_u32 s37, s21, 0
    s_and_b32 s37, s37, 0xffff
    s_mov_b32 s38, 262144
    s_mov_b32 s39, 0x20000
    s_mul_i32 s61, s69, 0
    s_and_b32 s61, s61, 63
    s_lshl_b32 s61, s61, 12
    s_mov_b32 s48, s34
    s_and_b32 s49, s35, 0xffff
    s_mov_b32 s50, 4194304
    s_mov_b32 s51, 0x20000
    s_mov_b32 s64, 1000000
    s_movk_i32 s65, 0xfff
    s_mov_b32 s66, 0xfffff000
    s_mov_b32 s67, 0x3e0293ee
    v_lshlrev_b32 v22, 4, v1
    v_and_b32 v4, 1, v2
    v_bfe_u32 v5, v2, 1, 2
    v_cmp_eq_u32 vcc, 1, v4
    v_mov_b32 v6, 0xffff
    v_mov_b32 v7, 0xffff0000
    v_cndmask_b32 v8, v6, v7, vcc
    v_mov_b32 v6, 0x0c0c0100
    v_mov_b32 v7, 0x01000c0c
    v_cndmask_b32 v24, v6, v7, vcc
    v_mov_b32 v6, 0x0c0c0302
    v_mov_b32 v7, 0x03020c0c
    v_cndmask_b32 v25, v6, v7, vcc
    v_mov_b32 v6, 0x0c0c0c0c
    v_cmp_eq_u32 vcc, 0, v5
    s_nop 1
    v_cndmask_b32 v10, 0, v8, vcc
    v_cndmask_b32 v14, v6, v24, vcc
    v_cndmask_b32 v15, v6, v25, vcc
    v_cmp_eq_u32 vcc, 1, v5
    s_nop 1
    v_cndmask_b32 v11, 0, v8, vcc
    v_cndmask_b32 v16, v6, v24, vcc
    v_cndmask_b32 v17, v6, v25, vcc
    v_cmp_eq_u32 vcc, 2, v5
    s_nop 1
    v_cndmask_b32 v12, 0, v8, vcc
    v_cndmask_b32 v18, v6, v24, vcc
    v_cndmask_b32 v19, v6, v25, vcc
    v_cmp_eq_u32 vcc, 3, v5
    s_nop 1
    v_cndmask_b32 v13, 0, v8, vcc
    v_cndmask_b32 v20, v6, v24, vcc
    v_cndmask_b32 v21, v6, v25, vcc
    s_lshr_b32 s58, s69, 5
    s_and_b32 s59, s69, 31
    s_lshr_b32 s57, s69, 1
    v_lshrrev_b32 v65, 5, v1
    v_and_b32 v66, 31, v1
    v_and_b32 v4, 3, v1
    v_bfe_u32 v5, v1, 2, 2
    v_lshl_add_u32 v6, v4, 2, v5
    v_xor_b32 v6, v6, v65
    v_lshlrev_b32 v7, 10, v66
    s_lshl_b32 s3, s56, 15
    v_xor_b32 v8, 0, v6
    v_lshl_add_u32 v8, v8, 4, v7
    v_add_u32 v44, s3, v8
    v_add_u32 v240, 131072, v8
    v_xor_b32 v8, 2, v6
    v_lshl_add_u32 v8, v8, 4, v7
    v_add_u32 v45, s3, v8
    v_add_u32 v241, 131072, v8
    v_xor_b32 v8, 4, v6
    v_lshl_add_u32 v8, v8, 4, v7
    v_add_u32 v46, s3, v8
    v_add_u32 v242, 131072, v8
    v_xor_b32 v8, 6, v6
    v_lshl_add_u32 v8, v8, 4, v7
    v_add_u32 v47, s3, v8
    v_add_u32 v243, 131072, v8
    v_xor_b32 v8, 8, v6
    v_lshl_add_u32 v8, v8, 4, v7
    v_add_u32 v48, s3, v8
    v_add_u32 v244, 131072, v8
    v_xor_b32 v8, 10, v6
    v_lshl_add_u32 v8, v8, 4, v7
    v_add_u32 v49, s3, v8
    v_add_u32 v245, 131072, v8
    v_xor_b32 v8, 12, v6
    v_lshl_add_u32 v8, v8, 4, v7
    v_add_u32 v50, s3, v8
    v_add_u32 v246, 131072, v8
    v_xor_b32 v8, 14, v6
    v_lshl_add_u32 v8, v8, 4, v7
    v_add_u32 v51, s3, v8
    v_add_u32 v247, 131072, v8
    v_bfe_u32 v6, v1, 4, 1
    v_lshrrev_b32 v7, 1, v4
    v_lshl_add_u32 v6, v6, 1, v7
    v_xor_b32 v6, v6, v65
    v_lshl_add_u32 v6, v5, 2, v6
    v_lshl_add_u32 v7, v65, 2, v5
    v_lshlrev_b32 v7, 10, v7
    v_and_b32 v8, 1, v1
    v_lshl_add_u32 v7, v8, 3, v7
    v_add_u32 v7, s63, v7
    v_xor_b32 v8, 0, v6
    v_lshl_add_u32 v52, v8, 4, v7
    v_xor_b32 v8, 2, v6
    v_lshl_add_u32 v53, v8, 4, v7
    v_add_u32 v53, 0x2000, v53
    v_xor_b32 v8, 4, v6
    v_lshl_add_u32 v54, v8, 4, v7
    v_xor_b32 v8, 6, v6
    v_lshl_add_u32 v55, v8, 4, v7
    v_add_u32 v55, 0x2000, v55
    v_xor_b32 v8, 8, v6
    v_lshl_add_u32 v56, v8, 4, v7
    v_xor_b32 v8, 10, v6
    v_lshl_add_u32 v57, v8, 4, v7
    v_add_u32 v57, 0x2000, v57
    v_xor_b32 v8, 12, v6
    v_lshl_add_u32 v58, v8, 4, v7
    v_xor_b32 v8, 14, v6
    v_lshl_add_u32 v59, v8, 4, v7
    v_add_u32 v59, 0x2000, v59
    s_waitcnt lgkmcnt(0)
    s_add_u32 s60, s60, 1
    v_mov_b32 v9, s60
    s_mov_b32 s40, s26
    s_and_b32 s41, s27, 0xffff
    s_mov_b32 s42, 4194304
    s_mov_b32 s43, 0x20000
    s_lshl_b32 s3, s57, 17
    s_add_u32 s44, s28, s3
    s_addc_u32 s45, s29, 0
    s_and_b32 s45, s45, 0xffff
    s_mov_b32 s46, 131072
    s_mov_b32 s47, 0x20000
    v_add_u32 v104, 0x10000, v52
    v_add_u32 v105, 0x10000, v53
    v_add_u32 v106, 0x10000, v54
    v_add_u32 v107, 0x10000, v55
    v_add_u32 v108, 0x10000, v56
    v_add_u32 v109, 0x10000, v57
    v_add_u32 v110, 0x10000, v58
    v_add_u32 v111, 0x10000, v59
    s_mov_b32 s0, 0
    s_cmp_lg_u32 s56, 3
    s_cbranch_scc1 L_noid_37
    s_getreg_b32 s3, hwreg(HW_REG_XCC_ID, 0, 4)
    s_xor_b32 s3, s3, s60
    v_mov_b32 v4, s3
    v_mov_b32 v5, s60
    s_and_b32 s3, s2, 7
    s_lshl_b32 s3, s3, 5
    s_lshr_b32 s0, s2, 3
    s_add_u32 s3, s3, s0
    s_lshl_b32 s3, s3, 3
    s_add_u32 s3, s3, 4096
    s_mov_b32 s0, 0
    v_mov_b32 v6, 0
    s_mov_b64 exec, 1
    buffer_store_dwordx2 v[4:5], v6, s[48:51], s3 offen
    s_mov_b64 exec, -1
L_noid_37:
    v_and_b32 v4, 3, v1
    v_lshlrev_b32 v4, 3, v4
    v_lshrrev_b32 v4, v4, v9
    s_mov_b32 s1, 0x10001
    v_bfe_u32 v5, v4, 1, 1
    v_bfe_u32 v6, v4, 0, 1
    v_lshl_or_b32 v40, v5, 16, v6
    v_bfe_u32 v5, v4, 3, 1
    v_bfe_u32 v6, v4, 2, 1
    v_lshl_or_b32 v41, v5, 16, v6
    v_bfe_u32 v5, v4, 5, 1
    v_bfe_u32 v6, v4, 4, 1
    v_lshl_or_b32 v42, v5, 16, v6
    v_bfe_u32 v5, v4, 7, 1
    v_bfe_u32 v6, v4, 6, 1
    v_lshl_or_b32 v43, v5, 16, v6
    s_lshl_b32 s3, s69, 2
    s_add_u32 s3, s3, s56
    s_cmp_lg_u32 s3, 1
    s_cbranch_scc1 L_nozero_38
    v_bfe_u32 v8, v1, 2, 2
    v_lshlrev_b32 v8, 7, v8
    v_lshl_add_u32 v8, v3, 9, v8
    v_and_b32 v4, 3, v1
    v_lshl_add_u32 v8, v4, 4, v8
    v_mov_b32 v4, 0
    v_mov_b32 v5, 0
    v_mov_b32 v6, 0
    v_mov_b32 v7, 0
    s_mov_b32 s3, 16384
    buffer_store_dwordx4 v[4:7], v8, s[48:51], s3 offen sc1
    s_mov_b32 s3, 18432
    buffer_store_dwordx4 v[4:7], v8, s[48:51], s3 offen sc1
    s_mov_b32 s3, 20480
    buffer_store_dwordx4 v[4:7], v8, s[48:51], s3 offen sc1
    s_mov_b32 s3, 22528
    buffer_store_dwordx4 v[4:7], v8, s[48:51], s3 offen sc1
    s_mov_b32 s3, 24576
    buffer_store_dwordx4 v[4:7], v8, s[48:51], s3 offen sc1
    s_mov_b32 s3, 26624
    buffer_store_dwordx4 v[4:7], v8, s[48:51], s3 offen sc1
    s_mov_b32 s3, 28672
    buffer_store_dwordx4 v[4:7], v8, s[48:51], s3 offen sc1
    s_mov_b32 s3, 30720
    buffer_store_dwordx4 v[4:7], v8, s[48:51], s3 offen sc1
    s_mov_b32 s3, 32768
    buffer_store_dwordx4 v[4:7], v8, s[48:51], s3 offen sc1
    s_mov_b32 s3, 34816
    buffer_store_dwordx4 v[4:7], v8, s[48:51], s3 offen sc1
    s_nop 1
L_nozero_38:
    s_lshl_b32 s59, s58, 15
    s_add_u32 s59, s59, 786432
    v_add_u32 v116, s62, v22
    s_and_b32 s3, s69, 1
    s_lshl2_add_u32 s3, s3, s56
    s_lshl_b32 s55, s3, 19
    s_lshl_b32 s3, s57, 8
    s_add_u32 s55, s55, s3
    v_lshlrev_b32 v4, 17, v3
    v_lshl_add_u32 v67, v2, 4, v4
    v_add_u32 v112, 131072, v36
    v_add_u32 v113, 131072, v37
    v_add_u32 v114, 131072, v38
    v_add_u32 v115, 131072, v39
    s_and_b32 s3, s69, 1
    s_lshl_b32 s3, s3, 1
    s_and_b32 s70, s56, 1
    s_add_u32 s70, s70, s3
    s_lshr_b32 s71, s56, 1
    s_lshl_b32 s3, s71, 8
    s_add_u32 s3, s3, s70
    s_lshl_b32 s3, s3, 8
    v_lshlrev_b32 v4, 10, v3
    v_lshl_add_u32 v4, v2, 4, v4
    v_add_u32 v68, s3, v4
    s_add_u32 m0, s62, 0
    s_nop 0
    buffer_load_dwordx4 v36, s[36:39], s61 offen nt lds
    s_addk_i32 s61, 0x1000
    s_bitset0_b32 s61, 18
    s_add_u32 m0, s62, 4096
    s_nop 0
    buffer_load_dwordx4 v37, s[36:39], s61 offen nt lds
    s_addk_i32 s61, 0x1000
    s_bitset0_b32 s61, 18
    s_waitcnt vmcnt(9)
    s_add_u32 m0, s62, 8192
    s_nop 0
    buffer_load_dwordx4 v38, s[36:39], s61 offen nt lds
    s_addk_i32 s61, 0x1000
    s_bitset0_b32 s61, 18
    s_waitcnt vmcnt(9)
    s_add_u32 m0, s62, 12288
    s_nop 0
    buffer_load_dwordx4 v39, s[36:39], s61 offen nt lds
    s_addk_i32 s61, 0x1000
    s_bitset0_b32 s61, 18
    s_waitcnt vmcnt(9)
    s_add_u32 m0, s62, 16384
    s_nop 0
    buffer_load_dwordx4 v36, s[36:39], s61 offen nt lds
    s_addk_i32 s61, 0x1000
    s_bitset0_b32 s61, 18
    s_waitcnt vmcnt(9)
    s_add_u32 m0, s62, 20480
    s_nop 0
    buffer_load_dwordx4 v37, s[36:39], s61 offen nt lds
    s_addk_i32 s61, 0x1000
    s_bitset0_b32 s61, 18
    s_waitcnt vmcnt(9)
    s_add_u32 m0, s62, 24576
    s_nop 0
    buffer_load_dwordx4 v38, s[36:39], s61 offen nt lds
    s_addk_i32 s61, 0x1000
    s_bitset0_b32 s61, 18
    s_waitcnt vmcnt(9)
    s_add_u32 m0, s62, 28672
    s_nop 0
    buffer_load_dwordx4 v39, s[36:39], s61 offen nt lds
    s_addk_i32 s61, 0x1000
    s_bitset0_b32 s61, 18
    s_waitcnt vmcnt(9)
    s_add_u32 m0, s62, 32768
    s_nop 0
    buffer_load_dwordx4 v36, s[36:39], s61 offen nt lds
    s_addk_i32 s61, 0x1000
    s_bitset0_b32 s61, 18
    s_waitcnt vmcnt(9)
    s_add_u32 m0, s62, 36864
    s_nop 0
    buffer_load_dwordx4 v37, s[36:39], s61 offen nt lds
    s_addk_i32 s61, 0x1000
    s_bitset0_b32 s61, 18
    s_waitcnt vmcnt(9)
    s_add_u32 m0, s62, 40960
    s_nop 0
    buffer_load_dwordx4 v38, s[36:39], s61 offen nt lds
    s_addk_i32 s61, 0x1000
    s_bitset0_b32 s61, 18
    s_waitcnt vmcnt(9)
    s_add_u32 m0, s62, 45056
    s_nop 0
    buffer_load_dwordx4 v39, s[36:39], s61 offen nt lds
    s_addk_i32 s61, 0x1000
    s_bitset0_b32 s61, 18
    s_waitcnt vmcnt(9)
    s_add_u32 m0, s62, 49152
    s_nop 0
    buffer_load_dwordx4 v36, s[36:39], s61 offen nt lds
    s_addk_i32 s61, 0x1000
    s_bitset0_b32 s61, 18
    s_waitcnt vmcnt(9)
    s_add_u32 m0, s62, 53248
    s_nop 0
    buffer_load_dwordx4 v37, s[36:39], s61 offen nt lds
    s_addk_i32 s61, 0x1000
    s_bitset0_b32 s61, 18
    s_waitcnt vmcnt(9)
    s_add_u32 m0, s62, 57344
    s_nop 0
    buffer_load_dwordx4 v38, s[36:39], s61 offen nt lds
    s_addk_i32 s61, 0x1000
    s_bitset0_b32 s61, 18
    s_waitcnt vmcnt(9)
    s_add_u32 m0, s62, 61440
    s_nop 0
    buffer_load_dwordx4 v39, s[36:39], s61 offen nt lds
    s_addk_i32 s61, 0x1000
    s_bitset0_b32 s61, 18
    s_waitcnt vmcnt(9)
    s_add_u32 m0, s62, 65536
    s_nop 0
    buffer_load_dwordx4 v36, s[36:39], s61 offen nt lds
    s_addk_i32 s61, 0x1000
    s_bitset0_b32 s61, 18
    s_waitcnt vmcnt(9)
    s_add_u32 m0, s62, 69632
    s_nop 0
    buffer_load_dwordx4 v37, s[36:39], s61 offen nt lds
    s_addk_i32 s61, 0x1000
    s_bitset0_b32 s61, 18
    s_waitcnt lgkmcnt(0)
    s_barrier
    ds_read_b64_tr_b16 a[0:1], v52 offset:0
    ds_read_b64_tr_b16 a[2:3], v53 offset:0
    ds_read_b64_tr_b16 a[4:5], v54 offset:0
    ds_read_b64_tr_b16 a[6:7], v55 offset:0
    ds_read_b64_tr_b16 a[8:9], v56 offset:0
    ds_read_b64_tr_b16 a[10:11], v57 offset:0
    ds_read_b64_tr_b16 a[12:13], v58 offset:0
    ds_read_b64_tr_b16 a[14:15], v59 offset:0
    ds_read_b64_tr_b16 a[16:17], v52 offset:16384
    ds_read_b64_tr_b16 a[18:19], v53 offset:16384
    ds_read_b64_tr_b16 a[20:21], v54 offset:16384
    ds_read_b64_tr_b16 a[22:23], v55 offset:16384
    ds_read_b64_tr_b16 a[24:25], v56 offset:16384
    ds_read_b64_tr_b16 a[26:27], v57 offset:16384
    ds_read_b64_tr_b16 a[28:29], v58 offset:16384
    ds_read_b64_tr_b16 a[30:31], v59 offset:16384
    s_cmp_lg_u32 s56, 0
    s_cbranch_scc1 L_notile_39
    ds_read_b128 a[128:131], v44 offset:0
    ds_read_b128 a[132:135], v45 offset:0
    ds_read_b128 a[136:139], v46 offset:0
    ds_read_b128 a[140:143], v47 offset:0
    ds_read_b128 a[144:147], v48 offset:0
    ds_read_b128 a[148:151], v49 offset:0
    ds_read_b128 a[152:155], v50 offset:0
    ds_read_b128 a[156:159], v51 offset:0
    ds_read_b128 a[160:163], v44 offset:256
    ds_read_b128 a[164:167], v45 offset:256
    ds_read_b128 a[168:171], v46 offset:256
    ds_read_b128 a[172:175], v47 offset:256
    ds_read_b128 a[176:179], v48 offset:256
    ds_read_b128 a[180:183], v49 offset:256
    ds_read_b128 a[184:187], v50 offset:256
    ds_read_b128 a[188:191], v51 offset:256
    ds_read_b128 a[192:195], v44 offset:512
    ds_read_b128 a[196:199], v45 offset:512
    ds_read_b128 a[200:203], v46 offset:512
    ds_read_b128 a[204:207], v47 offset:512
    ds_read_b128 a[208:211], v48 offset:512
    ds_read_b128 a[212:215], v49 offset:512
    ds_read_b128 a[216:219], v50 offset:512
    ds_read_b128 a[220:223], v51 offset:512
    ds_read_b128 a[224:227], v44 offset:768
    ds_read_b128 a[228:231], v45 offset:768
    ds_read_b128 a[232:235], v46 offset:768
    ds_read_b128 a[236:239], v47 offset:768
    ds_read_b128 a[240:243], v48 offset:768
    ds_read_b128 a[244:247], v49 offset:768
    ds_read_b128 a[248:251], v50 offset:768
    ds_read_b128 a[252:255], v51 offset:768
L_notile_39:
    s_waitcnt vmcnt(9)
    s_add_u32 m0, s62, 73728
    s_nop 0
    buffer_load_dwordx4 v38, s[36:39], s61 offen nt lds
    s_addk_i32 s61, 0x1000
    s_bitset0_b32 s61, 18
    s_waitcnt vmcnt(9)
    s_add_u32 m0, s62, 77824
    s_nop 0
    buffer_load_dwordx4 v39, s[36:39], s61 offen nt lds
    s_addk_i32 s61, 0x1000
    s_bitset0_b32 s61, 18
    s_waitcnt vmcnt(9)
    s_add_u32 m0, s62, 81920
    s_nop 0
    buffer_load_dwordx4 v36, s[36:39], s61 offen nt lds
    s_addk_i32 s61, 0x1000
    s_bitset0_b32 s61, 18
    s_waitcnt vmcnt(9)
    s_add_u32 m0, s62, 86016
    s_nop 0
    buffer_load_dwordx4 v37, s[36:39], s61 offen nt lds
    s_addk_i32 s61, 0x1000
    s_bitset0_b32 s61, 18
    s_waitcnt vmcnt(9)
    s_add_u32 m0, s62, 90112
    s_nop 0
    buffer_load_dwordx4 v38, s[36:39], s61 offen nt lds
    s_addk_i32 s61, 0x1000
    s_bitset0_b32 s61, 18
    s_waitcnt vmcnt(9)
    s_add_u32 m0, s62, 94208
    s_nop 0
    buffer_load_dwordx4 v39, s[36:39], s61 offen nt lds
    s_addk_i32 s61, 0x1000
    s_bitset0_b32 s61, 18
    s_waitcnt vmcnt(9)
    s_add_u32 m0, s62, 98304
    s_nop 0
    buffer_load_dwordx4 v36, s[36:39], s61 offen nt lds
    s_addk_i32 s61, 0x1000
    s_bitset0_b32 s61, 18
    s_waitcnt vmcnt(9)
    s_add_u32 m0, s62, 102400
    s_nop 0
    buffer_load_dwordx4 v37, s[36:39], s61 offen nt lds
    s_addk_i32 s61, 0x1000
    s_bitset0_b32 s61, 18
    s_waitcnt lgkmcnt(0)
    s_barrier
    ds_read_b64_tr_b16 a[32:33], v52 offset:32768
    ds_read_b64_tr_b16 a[34:35], v53 offset:32768
    ds_read_b64_tr_b16 a[36:37], v54 offset:32768
    ds_read_b64_tr_b16 a[38:39], v55 offset:32768
    ds_read_b64_tr_b16 a[40:41], v56 offset:32768
    ds_read_b64_tr_b16 a[42:43], v57 offset:32768
    ds_read_b64_tr_b16 a[44:45], v58 offset:32768
    ds_read_b64_tr_b16 a[46:47], v59 offset:32768
    ds_read_b64_tr_b16 a[48:49], v52 offset:49152
    ds_read_b64_tr_b16 a[50:51], v53 offset:49152
    ds_read_b64_tr_b16 a[52:53], v54 offset:49152
    ds_read_b64_tr_b16 a[54:55], v55 offset:49152
    ds_read_b64_tr_b16 a[56:57], v56 offset:49152
    ds_read_b64_tr_b16 a[58:59], v57 offset:49152
    ds_read_b64_tr_b16 a[60:61], v58 offset:49152
    ds_read_b64_tr_b16 a[62:63], v59 offset:49152
    s_cmp_lg_u32 s56, 1
    s_cbranch_scc1 L_notile_40
    ds_read_b128 a[128:131], v44 offset:0
    ds_read_b128 a[132:135], v45 offset:0
    ds_read_b128 a[136:139], v46 offset:0
    ds_read_b128 a[140:143], v47 offset:0
    ds_read_b128 a[144:147], v48 offset:0
    ds_read_b128 a[148:151], v49 offset:0
    ds_read_b128 a[152:155], v50 offset:0
    ds_read_b128 a[156:159], v51 offset:0
    ds_read_b128 a[160:163], v44 offset:256
    ds_read_b128 a[164:167], v45 offset:256
    ds_read_b128 a[168:171], v46 offset:256
    ds_read_b128 a[172:175], v47 offset:256
    ds_read_b128 a[176:179], v48 offset:256
    ds_read_b128 a[180:183], v49 offset:256
    ds_read_b128 a[184:187], v50 offset:256
    ds_read_b128 a[188:191], v51 offset:256
    ds_read_b128 a[192:195], v44 offset:512
    ds_read_b128 a[196:199], v45 offset:512
    ds_read_b128 a[200:203], v46 offset:512
    ds_read_b128 a[204:207], v47 offset:512
    ds_read_b128 a[208:211], v48 offset:512
    ds_read_b128 a[212:215], v49 offset:512
    ds_read_b128 a[216:219], v50 offset:512
    ds_read_b128 a[220:223], v51 offset:512
    ds_read_b128 a[224:227], v44 offset:768
    ds_read_b128 a[228:231], v45 offset:768
    ds_read_b128 a[232:235], v46 offset:768
    ds_read_b128 a[236:239], v47 offset:768
    ds_read_b128 a[240:243], v48 offset:768
    ds_read_b128 a[244:247], v49 offset:768
    ds_read_b128 a[248:251], v50 offset:768
    ds_read_b128 a[252:255], v51 offset:768
L_notile_40:
    s_and_b32 s3, s2, 7
    s_lshl_b32 s3, s3, 8
    s_add_u32 s3, s3, 4096
    v_and_b32 v4, 31, v1
    v_lshlrev_b32 v4, 3, v4
    buffer_load_dwordx2 v[248:249], v4, s[48:51], s3 offen sc1
    s_waitcnt vmcnt(9)
    s_add_u32 m0, s62, 106496
    s_nop 0
    buffer_load_dwordx4 v38, s[36:39], s61 offen nt lds
    s_addk_i32 s61, 0x1000
    s_bitset0_b32 s61, 18
    s_waitcnt vmcnt(9)
    s_add_u32 m0, s62, 110592
    s_nop 0
    buffer_load_dwordx4 v39, s[36:39], s61 offen nt lds
    s_addk_i32 s61, 0x1000
    s_bitset0_b32 s61, 18
    s_waitcnt vmcnt(9)
    s_add_u32 m0, s62, 114688
    s_nop 0
    buffer_load_dwordx4 v36, s[36:39], s61 offen nt lds
    s_addk_i32 s61, 0x1000
    s_bitset0_b32 s61, 18
    s_waitcnt vmcnt(9)
    s_add_u32 m0, s62, 118784
    s_nop 0
    buffer_load_dwordx4 v37, s[36:39], s61 offen nt lds
    s_addk_i32 s61, 0x1000
    s_bitset0_b32 s61, 18
    s_waitcnt vmcnt(9)
    s_add_u32 m0, s62, 122880
    s_nop 0
    buffer_load_dwordx4 v38, s[36:39], s61 offen nt lds
    s_addk_i32 s61, 0x1000
    s_bitset0_b32 s61, 18
    s_waitcnt vmcnt(9)
    s_add_u32 m0, s62, 126976
    s_nop 0
    buffer_load_dwordx4 v39, s[36:39], s61 offen nt lds
    s_addk_i32 s61, 0x1000
    s_bitset0_b32 s61, 18
    s_waitcnt vmcnt(9)
    s_add_u32 m0, s62, 0
    s_nop 0
    buffer_load_dwordx4 v36, s[36:39], s61 offen nt lds
    s_addk_i32 s61, 0x1000
    s_bitset0_b32 s61, 18
    s_waitcnt vmcnt(9)
    s_add_u32 m0, s62, 4096
    s_nop 0
    buffer_load_dwordx4 v37, s[36:39], s61 offen nt lds
    s_addk_i32 s61, 0x1000
    s_bitset0_b32 s61, 18
    s_waitcnt lgkmcnt(0)
    s_barrier
    ds_read_b64_tr_b16 a[64:65], v104 offset:0
    ds_read_b64_tr_b16 a[66:67], v105 offset:0
    ds_read_b64_tr_b16 a[68:69], v106 offset:0
    ds_read_b64_tr_b16 a[70:71], v107 offset:0
    ds_read_b64_tr_b16 a[72:73], v108 offset:0
    ds_read_b64_tr_b16 a[74:75], v109 offset:0
    ds_read_b64_tr_b16 a[76:77], v110 offset:0
    ds_read_b64_tr_b16 a[78:79], v111 offset:0
    ds_read_b64_tr_b16 a[80:81], v104 offset:16384
    ds_read_b64_tr_b16 a[82:83], v105 offset:16384
    ds_read_b64_tr_b16 a[84:85], v106 offset:16384
    ds_read_b64_tr_b16 a[86:87], v107 offset:16384
    ds_read_b64_tr_b16 a[88:89], v108 offset:16384
    ds_read_b64_tr_b16 a[90:91], v109 offset:16384
    ds_read_b64_tr_b16 a[92:93], v110 offset:16384
    ds_read_b64_tr_b16 a[94:95], v111 offset:16384
    s_cmp_lg_u32 s56, 2
    s_cbranch_scc1 L_notile_41
    ds_read_b128 a[128:131], v44 offset:0
    ds_read_b128 a[132:135], v45 offset:0
    ds_read_b128 a[136:139], v46 offset:0
    ds_read_b128 a[140:143], v47 offset:0
    ds_read_b128 a[144:147], v48 offset:0
    ds_read_b128 a[148:151], v49 offset:0
    ds_read_b128 a[152:155], v50 offset:0
    ds_read_b128 a[156:159], v51 offset:0
    ds_read_b128 a[160:163], v44 offset:256
    ds_read_b128 a[164:167], v45 offset:256
    ds_read_b128 a[168:171], v46 offset:256
    ds_read_b128 a[172:175], v47 offset:256
    ds_read_b128 a[176:179], v48 offset:256
    ds_read_b128 a[180:183], v49 offset:256
    ds_read_b128 a[184:187], v50 offset:256
    ds_read_b128 a[188:191], v51 offset:256
    ds_read_b128 a[192:195], v44 offset:512
    ds_read_b128 a[196:199], v45 offset:512
    ds_read_b128 a[200:203], v46 offset:512
    ds_read_b128 a[204:207], v47 offset:512
    ds_read_b128 a[208:211], v48 offset:512
    ds_read_b128 a[212:215], v49 offset:512
    ds_read_b128 a[216:219], v50 offset:512
    ds_read_b128 a[220:223], v51 offset:512
    ds_read_b128 a[224:227], v44 offset:768
    ds_read_b128 a[228:231], v45 offset:768
    ds_read_b128 a[232:235], v46 offset:768
    ds_read_b128 a[236:239], v47 offset:768
    ds_read_b128 a[240:243], v48 offset:768
    ds_read_b128 a[244:247], v49 offset:768
    ds_read_b128 a[248:251], v50 offset:768
    ds_read_b128 a[252:255], v51 offset:768
L_notile_41:
    s_waitcnt vmcnt(9)
    s_add_u32 m0, s62, 8192
    s_nop 0
    buffer_load_dwordx4 v38, s[36:39], s61 offen nt lds
    s_addk_i32 s61, 0x1000
    s_bitset0_b32 s61, 18
    s_waitcnt vmcnt(9)
    s_add_u32 m0, s62, 12288
    s_nop 0
    buffer_load_dwordx4 v39, s[36:39], s61 offen nt lds
    s_addk_i32 s61, 0x1000
    s_bitset0_b32 s61, 18
    s_waitcnt vmcnt(9)
    s_add_u32 m0, s62, 16384
    s_nop 0
    buffer_load_dwordx4 v36, s[36:39], s61 offen nt lds
    s_addk_i32 s61, 0x1000
    s_bitset0_b32 s61, 18
    s_waitcnt vmcnt(9)
    s_add_u32 m0, s62, 20480
    s_nop 0
    buffer_load_dwordx4 v37, s[36:39], s61 offen nt lds
    s_addk_i32 s61, 0x1000
    s_bitset0_b32 s61, 18
    s_waitcnt vmcnt(9)
    s_add_u32 m0, s62, 24576
    s_nop 0
    buffer_load_dwordx4 v38, s[36:39], s61 offen nt lds
    s_addk_i32 s61, 0x1000
    s_bitset0_b32 s61, 18
    s_waitcnt vmcnt(9)
    s_add_u32 m0, s62, 28672
    s_nop 0
    buffer_load_dwordx4 v39, s[36:39], s61 offen nt lds
    s_addk_i32 s61, 0x1000
    s_bitset0_b32 s61, 18
    s_waitcnt vmcnt(9)
    s_add_u32 m0, s62, 32768
    s_nop 0
    buffer_load_dwordx4 v36, s[36:39], s61 offen nt lds
    s_addk_i32 s61, 0x1000
    s_bitset0_b32 s61, 18
    s_waitcnt vmcnt(9)
    s_add_u32 m0, s62, 36864
    s_nop 0
    buffer_load_dwordx4 v37, s[36:39], s61 offen nt lds
    s_addk_i32 s61, 0x1000
    s_bitset0_b32 s61, 18
    s_waitcnt lgkmcnt(0)
    s_barrier
    ds_read_b64_tr_b16 a[96:97], v104 offset:32768
    ds_read_b64_tr_b16 a[98:99], v105 offset:32768
    ds_read_b64_tr_b16 a[100:101], v106 offset:32768
    ds_read_b64_tr_b16 a[102:103], v107 offset:32768
    ds_read_b64_tr_b16 a[104:105], v108 offset:32768
    ds_read_b64_tr_b16 a[106:107], v109 offset:32768
    ds_read_b64_tr_b16 a[108:109], v110 offset:32768
    ds_read_b64_tr_b16 a[110:111], v111 offset:32768
    ds_read_b64_tr_b16 a[112:113], v104 offset:49152
    ds_read_b64_tr_b16 a[114:115], v105 offset:49152
    ds_read_b64_tr_b16 a[116:117], v106 offset:49152
    ds_read_b64_tr_b16 a[118:119], v107 offset:49152
    ds_read_b64_tr_b16 a[120:121], v108 offset:49152
    ds_read_b64_tr_b16 a[122:123], v109 offset:49152
    ds_read_b64_tr_b16 a[124:125], v110 offset:49152
    ds_read_b64_tr_b16 a[126:127], v111 offset:49152
    s_cmp_lg_u32 s56, 3
    s_cbranch_scc1 L_notile_42
    ds_read_b128 a[128:131], v44 offset:0
    ds_read_b128 a[132:135], v45 offset:0
    ds_read_b128 a[136:139], v46 offset:0
    ds_read_b128 a[140:143], v47 offset:0
    ds_read_b128 a[144:147], v48 offset:0
    ds_read_b128 a[148:151], v49 offset:0
    ds_read_b128 a[152:155], v50 offset:0
    ds_read_b128 a[156:159], v51 offset:0
    ds_read_b128 a[160:163], v44 offset:256
    ds_read_b128 a[164:167], v45 offset:256
    ds_read_b128 a[168:171], v46 offset:256
    ds_read_b128 a[172:175], v47 offset:256
    ds_read_b128 a[176:179], v48 offset:256
    ds_read_b128 a[180:183], v49 offset:256
    ds_read_b128 a[184:187], v50 offset:256
    ds_read_b128 a[188:191], v51 offset:256
    ds_read_b128 a[192:195], v44 offset:512
    ds_read_b128 a[196:199], v45 offset:512
    ds_read_b128 a[200:203], v46 offset:512
    ds_read_b128 a[204:207], v47 offset:512
    ds_read_b128 a[208:211], v48 offset:512
    ds_read_b128 a[212:215], v49 offset:512
    ds_read_b128 a[216:219], v50 offset:512
    ds_read_b128 a[220:223], v51 offset:512
    ds_read_b128 a[224:227], v44 offset:768
    ds_read_b128 a[228:231], v45 offset:768
    ds_read_b128 a[232:235], v46 offset:768
    ds_read_b128 a[236:239], v47 offset:768
    ds_read_b128 a[240:243], v48 offset:768
    ds_read_b128 a[244:247], v49 offset:768
    ds_read_b128 a[248:251], v50 offset:768
    ds_read_b128 a[252:255], v51 offset:768
L_notile_42:
    s_getreg_b32 s3, hwreg(HW_REG_XCC_ID, 0, 4)
    s_xor_b32 s3, s3, s60
    v_xor_b32 v4, s3, v248
    v_bitop3_b32 v4, v4, v249, s60 bitop3:0xf6
    v_cmp_ne_u32 vcc, 0, v4
    s_cmp_eq_u64 vcc, 0
    s_cselect_b32 s0, 1, 0
    s_waitcnt vmcnt(9)
    s_add_u32 m0, s62, 40960
    s_nop 0
    buffer_load_dwordx4 v38, s[36:39], s61 offen nt lds
    s_addk_i32 s61, 0x1000
    s_bitset0_b32 s61, 18
    s_waitcnt vmcnt(9)
    s_add_u32 m0, s62, 45056
    s_nop 0
    buffer_load_dwordx4 v39, s[36:39], s61 offen nt lds
    s_addk_i32 s61, 0x1000
    s_bitset0_b32 s61, 18
    s_waitcnt vmcnt(9)
    s_add_u32 m0, s62, 49152
    s_nop 0
    buffer_load_dwordx4 v36, s[36:39], s61 offen nt lds
    s_addk_i32 s61, 0x1000
    s_bitset0_b32 s61, 18
    s_waitcnt vmcnt(9)
    s_add_u32 m0, s62, 53248
    s_nop 0
    buffer_load_dwordx4 v37, s[36:39], s61 offen nt lds
    s_addk_i32 s61, 0x1000
    s_bitset0_b32 s61, 18
    s_waitcnt vmcnt(9)
    s_add_u32 m0, s62, 57344
    s_nop 0
    buffer_load_dwordx4 v38, s[36:39], s61 offen nt lds
    s_addk_i32 s61, 0x1000
    s_bitset0_b32 s61, 18
    s_waitcnt vmcnt(9)
    s_add_u32 m0, s62, 61440
    s_nop 0
    buffer_load_dwordx4 v39, s[36:39], s61 offen nt lds
    s_addk_i32 s61, 0x1000
    s_bitset0_b32 s61, 18
    s_waitcnt vmcnt(9)
    s_add_u32 m0, s62, 65536
    s_nop 0
    buffer_load_dwordx4 v36, s[36:39], s61 offen nt lds
    s_addk_i32 s61, 0x1000
    s_bitset0_b32 s61, 18
    s_waitcnt vmcnt(9)
    s_add_u32 m0, s62, 69632
    s_nop 0
    buffer_load_dwordx4 v37, s[36:39], s61 offen nt lds
    s_addk_i32 s61, 0x1000
    s_bitset0_b32 s61, 18
    s_movk_i32 s68, 0xff
    s_add_u32 s3, s59, 0
    buffer_load_dwordx4 v[72:75], v116, s[48:51], s3 offen sc1
    s_add_u32 s3, s59, 4096
    buffer_load_dwordx4 v[76:79], v116, s[48:51], s3 offen sc1
    s_add_u32 s3, s59, 8192
    buffer_load_dwordx4 v[80:83], v116, s[48:51], s3 offen sc1
    s_add_u32 s3, s59, 12288
    buffer_load_dwordx4 v[84:87], v116, s[48:51], s3 offen sc1
    s_waitcnt vmcnt(13)
    s_add_u32 s3, s59, 16384
    buffer_load_dwordx4 v[88:91], v116, s[48:51], s3 offen sc1
    s_waitcnt vmcnt(13)
    s_add_u32 s3, s59, 20480
    buffer_load_dwordx4 v[92:95], v116, s[48:51], s3 offen sc1
    s_waitcnt vmcnt(13)
    s_add_u32 s3, s59, 24576
    buffer_load_dwordx4 v[96:99], v116, s[48:51], s3 offen sc1
    s_waitcnt vmcnt(13)
    s_add_u32 s3, s59, 28672
    buffer_load_dwordx4 v[100:103], v116, s[48:51], s3 offen sc1
    s_add_u32 m0, s62, 73728
    s_nop 0
    buffer_load_dwordx4 v38, s[36:39], s61 offen nt lds
    s_addk_i32 s61, 0x1000
    s_bitset0_b32 s61, 18
    s_add_u32 m0, s62, 77824
    s_nop 0
    buffer_load_dwordx4 v39, s[36:39], s61 offen nt lds
    s_addk_i32 s61, 0x1000
    s_bitset0_b32 s61, 18
    s_waitcnt vmcnt(9)
    v_xor_b32 v72, v40, v72
    v_xor_b32 v73, v41, v73
    v_xor_b32 v74, v42, v74
    v_xor_b32 v75, v43, v75
    v_or3_b32 v4, v72, v73, v74
    v_bitop3_b32 v4, v4, v75, s1 bitop3:0xa8
    v_cmp_ne_u32 vcc, 0, v4
    s_cbranch_vccnz L_qc_43
    s_bitset0_b32 s68, 0
    ds_write_b128 v112, v[72:75] offset:0
L_qc_43:
    s_add_u32 m0, s62, 81920
    s_nop 0
    buffer_load_dwordx4 v36, s[36:39], s61 offen nt lds
    s_addk_i32 s61, 0x1000
    s_bitset0_b32 s61, 18
    s_add_u32 m0, s62, 86016
    s_nop 0
    buffer_load_dwordx4 v37, s[36:39], s61 offen nt lds
    s_addk_i32 s61, 0x1000
    s_bitset0_b32 s61, 18
    s_waitcnt vmcnt(10)
    v_xor_b32 v76, v40, v76
    v_xor_b32 v77, v41, v77
    v_xor_b32 v78, v42, v78
    v_xor_b32 v79, v43, v79
    v_or3_b32 v4, v76, v77, v78
    v_bitop3_b32 v4, v4, v79, s1 bitop3:0xa8
    v_cmp_ne_u32 vcc, 0, v4
    s_cbranch_vccnz L_qc_44
    s_bitset0_b32 s68, 1
    ds_write_b128 v113, v[76:79] offset:4096
L_qc_44:
    s_add_u32 m0, s62, 90112
    s_nop 0
    buffer_load_dwordx4 v38, s[36:39], s61 offen nt lds
    s_addk_i32 s61, 0x1000
    s_bitset0_b32 s61, 18
    s_add_u32 m0, s62, 94208
    s_nop 0
    buffer_load_dwordx4 v39, s[36:39], s61 offen nt lds
    s_addk_i32 s61, 0x1000
    s_bitset0_b32 s61, 18
    s_waitcnt vmcnt(11)
    v_xor_b32 v80, v40, v80
    v_xor_b32 v81, v41, v81
    v_xor_b32 v82, v42, v82
    v_xor_b32 v83, v43, v83
    v_or3_b32 v4, v80, v81, v82
    v_bitop3_b32 v4, v4, v83, s1 bitop3:0xa8
    v_cmp_ne_u32 vcc, 0, v4
    s_cbranch_vccnz L_qc_45
    s_bitset0_b32 s68, 2
    ds_write_b128 v114, v[80:83] offset:8192
L_qc_45:
    s_waitcnt lgkmcnt(0)
    s_barrier
    s_add_u32 m0, s62, 98304
    s_nop 0
    buffer_load_dwordx4 v36, s[36:39], s61 offen nt lds
    s_addk_i32 s61, 0x1000
    s_bitset0_b32 s61, 18
    s_add_u32 m0, s62, 102400
    s_nop 0
    buffer_load_dwordx4 v37, s[36:39], s61 offen nt lds
    s_addk_i32 s61, 0x1000
    s_bitset0_b32 s61, 18
    s_waitcnt vmcnt(12)
    v_xor_b32 v84, v40, v84
    v_xor_b32 v85, v41, v85
    v_xor_b32 v86, v42, v86
    v_xor_b32 v87, v43, v87
    v_or3_b32 v4, v84, v85, v86
    v_bitop3_b32 v4, v4, v87, s1 bitop3:0xa8
    v_cmp_ne_u32 vcc, 0, v4
    s_cbranch_vccnz L_qc_46
    s_bitset0_b32 s68, 3
    ds_write_b128 v115, v[84:87] offset:12288
L_qc_46:
    s_add_u32 m0, s62, 106496
    s_nop 0
    buffer_load_dwordx4 v38, s[36:39], s61 offen nt lds
    s_addk_i32 s61, 0x1000
    s_bitset0_b32 s61, 18
    s_add_u32 m0, s62, 110592
    s_nop 0
    buffer_load_dwordx4 v39, s[36:39], s61 offen nt lds
    s_addk_i32 s61, 0x1000
    s_bitset0_b32 s61, 18
    s_waitcnt vmcnt(13)
    v_xor_b32 v88, v40, v88
    v_xor_b32 v89, v41, v89
    v_xor_b32 v90, v42, v90
    v_xor_b32 v91, v43, v91
    v_or3_b32 v4, v88, v89, v90
    v_bitop3_b32 v4, v4, v91, s1 bitop3:0xa8
    v_cmp_ne_u32 vcc, 0, v4
    s_cbranch_vccnz L_qc_47
    s_bitset0_b32 s68, 4
    ds_write_b128 v112, v[88:91] offset:16384
L_qc_47:
    s_add_u32 m0, s62, 114688
    s_nop 0
    buffer_load_dwordx4 v36, s[36:39], s61 offen nt lds
    s_addk_i32 s61, 0x1000
    s_bitset0_b32 s61, 18
    s_add_u32 m0, s62, 118784
    s_nop 0
    buffer_load_dwordx4 v37, s[36:39], s61 offen nt lds
    s_addk_i32 s61, 0x1000
    s_bitset0_b32 s61, 18
    s_waitcnt vmcnt(14)
    v_xor_b32 v92, v40, v92
    v_xor_b32 v93, v41, v93
    v_xor_b32 v94, v42, v94
    v_xor_b32 v95, v43, v95
    v_or3_b32 v4, v92, v93, v94
    v_bitop3_b32 v4, v4, v95, s1 bitop3:0xa8
    v_cmp_ne_u32 vcc, 0, v4
    s_cbranch_vccnz L_qc_48
    s_bitset0_b32 s68, 5
    ds_write_b128 v113, v[92:95] offset:20480
L_qc_48:
    s_add_u32 m0, s62, 122880
    s_nop 0
    buffer_load_dwordx4 v38, s[36:39], s61 offen nt lds
    s_addk_i32 s61, 0x1000
    s_bitset0_b32 s61, 18
    s_add_u32 m0, s62, 126976
    s_nop 0
    buffer_load_dwordx4 v39, s[36:39], s61 offen nt lds
    s_addk_i32 s61, 0x1000
    s_bitset0_b32 s61, 18
    s_waitcnt vmcnt(15)
    v_xor_b32 v96, v40, v96
    v_xor_b32 v97, v41, v97
    v_xor_b32 v98, v42, v98
    v_xor_b32 v99, v43, v99
    v_or3_b32 v4, v96, v97, v98
    v_bitop3_b32 v4, v4, v99, s1 bitop3:0xa8
    v_cmp_ne_u32 vcc, 0, v4
    s_cbranch_vccnz L_qc_49
    s_bitset0_b32 s68, 6
    ds_write_b128 v114, v[96:99] offset:24576
L_qc_49:
    s_waitcnt vmcnt(14)
    v_xor_b32 v100, v40, v100
    v_xor_b32 v101, v41, v101
    v_xor_b32 v102, v42, v102
    v_xor_b32 v103, v43, v103
    v_or3_b32 v4, v100, v101, v102
    v_bitop3_b32 v4, v4, v103, s1 bitop3:0xa8
    v_cmp_ne_u32 vcc, 0, v4
    s_cbranch_vccnz L_qc_50
    s_bitset0_b32 s68, 7
    ds_write_b128 v115, v[100:103] offset:28672
L_qc_50:
L_qtop_51:
    s_cmp_eq_u32 s68, 0
    s_cbranch_scc1 L_qout_52
    s_cmp_eq_u32 s64, 0
    s_cbranch_scc1 L_qout_52
    s_sub_u32 s64, s64, 1
    s_bitcmp0_b32 s68, 0
    s_cbranch_scc1 L_qs_53
    s_add_u32 s3, s59, 0
    buffer_load_dwordx4 v[72:75], v116, s[48:51], s3 offen sc1
L_qs_53:
    s_bitcmp0_b32 s68, 1
    s_cbranch_scc1 L_qs_54
    s_add_u32 s3, s59, 4096
    buffer_load_dwordx4 v[76:79], v116, s[48:51], s3 offen sc1
L_qs_54:
    s_bitcmp0_b32 s68, 2
    s_cbranch_scc1 L_qs_55
    s_add_u32 s3, s59, 8192
    buffer_load_dwordx4 v[80:83], v116, s[48:51], s3 offen sc1
L_qs_55:
    s_bitcmp0_b32 s68, 3
    s_cbranch_scc1 L_qs_56
    s_add_u32 s3, s59, 12288
    buffer_load_dwordx4 v[84:87], v116, s[48:51], s3 offen sc1
L_qs_56:
    s_bitcmp0_b32 s68, 4
    s_cbranch_scc1 L_qs_57
    s_add_u32 s3, s59, 16384
    buffer_load_dwordx4 v[88:91], v116, s[48:51], s3 offen sc1
L_qs_57:
    s_bitcmp0_b32 s68, 5
    s_cbranch_scc1 L_qs_58
    s_add_u32 s3, s59, 20480
    buffer_load_dwordx4 v[92:95], v116, s[48:51], s3 offen sc1
L_qs_58:
    s_bitcmp0_b32 s68, 6
    s_cbranch_scc1 L_qs_59
    s_add_u32 s3, s59, 24576
    buffer_load_dwordx4 v[96:99], v116, s[48:51], s3 offen sc1
L_qs_59:
    s_bitcmp0_b32 s68, 7
    s_cbranch_scc1 L_qs_60
    s_add_u32 s3, s59, 28672
    buffer_load_dwordx4 v[100:103], v116, s[48:51], s3 offen sc1
L_qs_60:
    s_waitcnt vmcnt(0)
    s_bitcmp0_b32 s68, 0
    s_cbranch_scc1 L_qc_61
    v_xor_b32 v72, v40, v72
    v_xor_b32 v73, v41, v73
    v_xor_b32 v74, v42, v74
    v_xor_b32 v75, v43, v75
    v_or3_b32 v4, v72, v73, v74
    v_bitop3_b32 v4, v4, v75, s1 bitop3:0xa8
    v_cmp_ne_u32 vcc, 0, v4
    s_cbranch_vccnz L_qc_61
    s_bitset0_b32 s68, 0
    ds_write_b128 v112, v[72:75] offset:0
L_qc_61:
    s_bitcmp0_b32 s68, 1
    s_cbranch_scc1 L_qc_62
    v_xor_b32 v76, v40, v76
    v_xor_b32 v77, v41, v77
    v_xor_b32 v78, v42, v78
    v_xor_b32 v79, v43, v79
    v_or3_b32 v4, v76, v77, v78
    v_bitop3_b32 v4, v4, v79, s1 bitop3:0xa8
    v_cmp_ne_u32 vcc, 0, v4
    s_cbranch_vccnz L_qc_62
    s_bitset0_b32 s68, 1
    ds_write_b128 v113, v[76:79] offset:4096
L_qc_62:
    s_bitcmp0_b32 s68, 2
    s_cbranch_scc1 L_qc_63
    v_xor_b32 v80, v40, v80
    v_xor_b32 v81, v41, v81
    v_xor_b32 v82, v42, v82
    v_xor_b32 v83, v43, v83
    v_or3_b32 v4, v80, v81, v82
    v_bitop3_b32 v4, v4, v83, s1 bitop3:0xa8
    v_cmp_ne_u32 vcc, 0, v4
    s_cbranch_vccnz L_qc_63
    s_bitset0_b32 s68, 2
    ds_write_b128 v114, v[80:83] offset:8192
L_qc_63:
    s_bitcmp0_b32 s68, 3
    s_cbranch_scc1 L_qc_64
    v_xor_b32 v84, v40, v84
    v_xor_b32 v85, v41, v85
    v_xor_b32 v86, v42, v86
    v_xor_b32 v87, v43, v87
    v_or3_b32 v4, v84, v85, v86
    v_bitop3_b32 v4, v4, v87, s1 bitop3:0xa8
    v_cmp_ne_u32 vcc, 0, v4
    s_cbranch_vccnz L_qc_64
    s_bitset0_b32 s68, 3
    ds_write_b128 v115, v[84:87] offset:12288
L_qc_64:
    s_bitcmp0_b32 s68, 4
    s_cbranch_scc1 L_qc_65
    v_xor_b32 v88, v40, v88
    v_xor_b32 v89, v41, v89
    v_xor_b32 v90, v42, v90
    v_xor_b32 v91, v43, v91
    v_or3_b32 v4, v88, v89, v90
    v_bitop3_b32 v4, v4, v91, s1 bitop3:0xa8
    v_cmp_ne_u32 vcc, 0, v4
    s_cbranch_vccnz L_qc_65
    s_bitset0_b32 s68, 4
    ds_write_b128 v112, v[88:91] offset:16384
L_qc_65:
    s_bitcmp0_b32 s68, 5
    s_cbranch_scc1 L_qc_66
    v_xor_b32 v92, v40, v92
    v_xor_b32 v93, v41, v93
    v_xor_b32 v94, v42, v94
    v_xor_b32 v95, v43, v95
    v_or3_b32 v4, v92, v93, v94
    v_bitop3_b32 v4, v4, v95, s1 bitop3:0xa8
    v_cmp_ne_u32 vcc, 0, v4
    s_cbranch_vccnz L_qc_66
    s_bitset0_b32 s68, 5
    ds_write_b128 v113, v[92:95] offset:20480
L_qc_66:
    s_bitcmp0_b32 s68, 6
    s_cbranch_scc1 L_qc_67
    v_xor_b32 v96, v40, v96
    v_xor_b32 v97, v41, v97
    v_xor_b32 v98, v42, v98
    v_xor_b32 v99, v43, v99
    v_or3_b32 v4, v96, v97, v98
    v_bitop3_b32 v4, v4, v99, s1 bitop3:0xa8
    v_cmp_ne_u32 vcc, 0, v4
    s_cbranch_vccnz L_qc_67
    s_bitset0_b32 s68, 6
    ds_write_b128 v114, v[96:99] offset:24576
L_qc_67:
    s_bitcmp0_b32 s68, 7
    s_cbranch_scc1 L_qc_68
    v_xor_b32 v100, v40, v100
    v_xor_b32 v101, v41, v101
    v_xor_b32 v102, v42, v102
    v_xor_b32 v103, v43, v103
    v_or3_b32 v4, v100, v101, v102
    v_bitop3_b32 v4, v4, v103, s1 bitop3:0xa8
    v_cmp_ne_u32 vcc, 0, v4
    s_cbranch_vccnz L_qc_68
    s_bitset0_b32 s68, 7
    ds_write_b128 v115, v[100:103] offset:28672
L_qc_68:
    s_branch L_qtop_51
L_qout_52:
    s_waitcnt vmcnt(0)
    s_lshl_b32 s3, s69, 2
    s_add_u32 s3, s3, s56
    s_cmp_lg_u32 s3, 1
    s_cbranch_scc1 L_noflag_69
    v_mov_b32 v8, s60
    v_mov_b32 v4, 14336
    s_mov_b64 exec, 1
    buffer_store_dwordx2 v[8:9], v4, s[48:51], 0 offen sc1
    s_mov_b64 exec, -1
L_noflag_69:
    s_lshl_b32 s3, s69, 10
    s_add_u32 s3, s3, 458752
    s_cmp_lg_u32 s56, 1
    s_cbranch_scc1 L_nowarm_70
    v_min_u32 v4, 7, v1
    v_lshlrev_b32 v4, 7, v4
    buffer_load_dword v71, v4, s[48:51], s3 offen
L_nowarm_70:
    s_lshl_b32 s3, s69, 9
    s_add_u32 s3, s3, 393216
    s_cmp_lg_u32 s56, 2
    s_cbranch_scc1 L_nowarm_71
    v_min_u32 v4, 3, v1
    v_lshlrev_b32 v4, 7, v4
    buffer_load_dword v71, v4, s[48:51], s3 offen
L_nowarm_71:
    s_lshr_b32 s3, s69, 3
    s_lshl_b32 s3, s3, 11
    s_add_u32 s3, s3, 360448
    s_cmp_lg_u32 s56, 3
    s_cbranch_scc1 L_nowarm_72
    v_min_u32 v4, 9, v1
    v_lshlrev_b32 v4, 7, v4
    buffer_load_dword v71, v4, s[48:51], s3 offen
L_nowarm_72:
    s_waitcnt lgkmcnt(0)
    s_barrier
    ds_read_b128 v[112:115], v240 offset:0
    ds_read_b128 v[116:119], v44 offset:0
    ds_read_b128 v[120:123], v241 offset:0
    ds_read_b128 v[124:127], v45 offset:0
    ds_read_b128 v[128:131], v242 offset:0
    ds_read_b128 v[132:135], v46 offset:0
    ds_read_b128 v[136:139], v243 offset:0
    ds_read_b128 v[140:143], v47 offset:0
    s_waitcnt lgkmcnt(6)
    v_mfma_f32_32x32x16_bf16 v[72:87], a[128:131], v[112:115], 0
    buffer_load_dwordx4 v[176:179], v67, s[40:43], s55 offen nt
    s_add_u32 s55, s55, 0x2000
    v_mfma_f32_32x32x16_bf16 v[88:103], v[116:119], v[112:115], 0
    ds_read_b128 v[112:115], v244 offset:0
    ds_read_b128 v[116:119], v48 offset:0
    s_waitcnt lgkmcnt(6)
    v_mfma_f32_32x32x16_bf16 v[72:87], a[132:135], v[120:123], v[72:87]
    buffer_load_dwordx4 v[180:183], v67, s[40:43], s55 offen nt
    s_add_u32 s55, s55, 0x2000
    v_mfma_f32_32x32x16_bf16 v[88:103], v[124:127], v[120:123], v[88:103]
    ds_read_b128 v[120:123], v245 offset:0
    ds_read_b128 v[124:127], v49 offset:0
    s_waitcnt lgkmcnt(6)
    v_mfma_f32_32x32x16_bf16 v[72:87], a[136:139], v[128:131], v[72:87]
    buffer_load_dwordx4 v[184:187], v67, s[40:43], s55 offen nt
    s_add_u32 s55, s55, 0x2000
    v_mfma_f32_32x32x16_bf16 v[88:103], v[132:135], v[128:131], v[88:103]
    ds_read_b128 v[128:131], v246 offset:0
    ds_read_b128 v[132:135], v50 offset:0
    s_waitcnt lgkmcnt(6)
    v_mfma_f32_32x32x16_bf16 v[72:87], a[140:143], v[136:139], v[72:87]
    buffer_load_dwordx4 v[188:191], v67, s[40:43], s55 offen nt
    s_add_u32 s55, s55, 0x2000
    v_mfma_f32_32x32x16_bf16 v[88:103], v[140:143], v[136:139], v[88:103]
    ds_read_b128 v[136:139], v247 offset:0
    ds_read_b128 v[140:143], v51 offset:0
    s_waitcnt lgkmcnt(6)
    v_mfma_f32_32x32x16_bf16 v[72:87], a[144:147], v[112:115], v[72:87]
    buffer_load_dwordx4 v[192:195], v67, s[40:43], s55 offen nt
    s_add_u32 s55, s55, 0x2000
    v_mfma_f32_32x32x16_bf16 v[88:103], v[116:119], v[112:115], v[88:103]
    ds_read_b128 v[112:115], v240 offset:256
    ds_read_b128 v[116:119], v44 offset:256
    s_waitcnt lgkmcnt(6)
    v_mfma_f32_32x32x16_bf16 v[72:87], a[148:151], v[120:123], v[72:87]
    buffer_load_dwordx4 v[196:199], v67, s[40:43], s55 offen nt
    s_add_u32 s55, s55, 0x2000
    v_mfma_f32_32x32x16_bf16 v[88:103], v[124:127], v[120:123], v[88:103]
    ds_read_b128 v[120:123], v241 offset:256
    ds_read_b128 v[124:127], v45 offset:256
    s_waitcnt lgkmcnt(6)
    v_mfma_f32_32x32x16_bf16 v[72:87], a[152:155], v[128:131], v[72:87]
    buffer_load_dwordx4 v[200:203], v67, s[40:43], s55 offen nt
    s_add_u32 s55, s55, 0x2000
    v_mfma_f32_32x32x16_bf16 v[88:103], v[132:135], v[128:131], v[88:103]
    ds_read_b128 v[128:131], v242 offset:256
    ds_read_b128 v[132:135], v46 offset:256
    s_waitcnt lgkmcnt(6)
    v_mfma_f32_32x32x16_bf16 v[72:87], a[156:159], v[136:139], v[72:87]
    buffer_load_dwordx4 v[204:207], v67, s[40:43], s55 offen nt
    s_add_u32 s55, s55, 0x2000
    v_mfma_f32_32x32x16_bf16 v[88:103], v[140:143], v[136:139], v[88:103]
    ds_read_b128 v[136:139], v243 offset:256
    ds_read_b128 v[140:143], v47 offset:256
    s_waitcnt lgkmcnt(6)
    v_mfma_f32_32x32x16_bf16 v[72:87], a[160:163], v[112:115], v[72:87]
    v_mfma_f32_32x32x16_bf16 v[88:103], v[116:119], v[112:115], v[88:103]
    ds_read_b128 v[112:115], v244 offset:256
    ds_read_b128 v[116:119], v48 offset:256
    s_waitcnt lgkmcnt(6)
    v_mfma_f32_32x32x16_bf16 v[72:87], a[164:167], v[120:123], v[72:87]
    v_mfma_f32_32x32x16_bf16 v[88:103], v[124:127], v[120:123], v[88:103]
    ds_read_b128 v[120:123], v245 offset:256
    ds_read_b128 v[124:127], v49 offset:256
    s_waitcnt lgkmcnt(6)
    v_mfma_f32_32x32x16_bf16 v[72:87], a[168:171], v[128:131], v[72:87]
    v_mfma_f32_32x32x16_bf16 v[88:103], v[132:135], v[128:131], v[88:103]
    ds_read_b128 v[128:131], v246 offset:256
    ds_read_b128 v[132:135], v50 offset:256
    s_waitcnt lgkmcnt(6)
    v_mfma_f32_32x32x16_bf16 v[72:87], a[172:175], v[136:139], v[72:87]
    v_mfma_f32_32x32x16_bf16 v[88:103], v[140:143], v[136:139], v[88:103]
    ds_read_b128 v[136:139], v247 offset:256
    ds_read_b128 v[140:143], v51 offset:256
    s_waitcnt lgkmcnt(6)
    v_mfma_f32_32x32x16_bf16 v[72:87], a[176:179], v[112:115], v[72:87]
    v_mfma_f32_32x32x16_bf16 v[88:103], v[116:119], v[112:115], v[88:103]
    ds_read_b128 v[112:115], v240 offset:512
    ds_read_b128 v[116:119], v44 offset:512
    s_waitcnt lgkmcnt(6)
    v_mfma_f32_32x32x16_bf16 v[72:87], a[180:183], v[120:123], v[72:87]
    v_mfma_f32_32x32x16_bf16 v[88:103], v[124:127], v[120:123], v[88:103]
    ds_read_b128 v[120:123], v241 offset:512
    ds_read_b128 v[124:127], v45 offset:512
    s_waitcnt lgkmcnt(6)
    v_mfma_f32_32x32x16_bf16 v[72:87], a[184:187], v[128:131], v[72:87]
    v_mfma_f32_32x32x16_bf16 v[88:103], v[132:135], v[128:131], v[88:103]
    ds_read_b128 v[128:131], v242 offset:512
    ds_read_b128 v[132:135], v46 offset:512
    s_waitcnt lgkmcnt(6)
    v_mfma_f32_32x32x16_bf16 v[72:87], a[188:191], v[136:139], v[72:87]
    v_mfma_f32_32x32x16_bf16 v[88:103], v[140:143], v[136:139], v[88:103]
    ds_read_b128 v[136:139], v243 offset:512
    ds_read_b128 v[140:143], v47 offset:512
    s_waitcnt lgkmcnt(6)
    v_mfma_f32_32x32x16_bf16 v[72:87], a[192:195], v[112:115], v[72:87]
    v_mfma_f32_32x32x16_bf16 v[88:103], v[116:119], v[112:115], v[88:103]
    ds_read_b128 v[112:115], v244 offset:512
    ds_read_b128 v[116:119], v48 offset:512
    s_waitcnt lgkmcnt(6)
    v_mfma_f32_32x32x16_bf16 v[72:87], a[196:199], v[120:123], v[72:87]
    v_mfma_f32_32x32x16_bf16 v[88:103], v[124:127], v[120:123], v[88:103]
    ds_read_b128 v[120:123], v245 offset:512
    ds_read_b128 v[124:127], v49 offset:512
    s_waitcnt lgkmcnt(6)
    v_mfma_f32_32x32x16_bf16 v[72:87], a[200:203], v[128:131], v[72:87]
    v_mfma_f32_32x32x16_bf16 v[88:103], v[132:135], v[128:131], v[88:103]
    ds_read_b128 v[128:131], v246 offset:512
    ds_read_b128 v[132:135], v50 offset:512
    s_waitcnt lgkmcnt(6)
    v_mfma_f32_32x32x16_bf16 v[72:87], a[204:207], v[136:139], v[72:87]
    v_mfma_f32_32x32x16_bf16 v[88:103], v[140:143], v[136:139], v[88:103]
    ds_read_b128 v[136:139], v247 offset:512
    ds_read_b128 v[140:143], v51 offset:512
    s_waitcnt lgkmcnt(6)
    v_mfma_f32_32x32x16_bf16 v[72:87], a[208:211], v[112:115], v[72:87]
    v_mfma_f32_32x32x16_bf16 v[88:103], v[116:119], v[112:115], v[88:103]
    ds_read_b128 v[112:115], v240 offset:768
    ds_read_b128 v[116:119], v44 offset:768
    s_waitcnt lgkmcnt(6)
    v_mfma_f32_32x32x16_bf16 v[72:87], a[212:215], v[120:123], v[72:87]
    v_mfma_f32_32x32x16_bf16 v[88:103], v[124:127], v[120:123], v[88:103]
    ds_read_b128 v[120:123], v241 offset:768
    ds_read_b128 v[124:127], v45 offset:768
    s_waitcnt lgkmcnt(6)
    v_mfma_f32_32x32x16_bf16 v[72:87], a[216:219], v[128:131], v[72:87]
    v_mfma_f32_32x32x16_bf16 v[88:103], v[132:135], v[128:131], v[88:103]
    ds_read_b128 v[128:131], v242 offset:768
    ds_read_b128 v[132:135], v46 offset:768
    s_waitcnt lgkmcnt(6)
    v_mfma_f32_32x32x16_bf16 v[72:87], a[220:223], v[136:139], v[72:87]
    v_mfma_f32_32x32x16_bf16 v[88:103], v[140:143], v[136:139], v[88:103]
    ds_read_b128 v[136:139], v243 offset:768
    ds_read_b128 v[140:143], v47 offset:768
    s_waitcnt lgkmcnt(6)
    v_mfma_f32_32x32x16_bf16 v[72:87], a[224:227], v[112:115], v[72:87]
    v_mfma_f32_32x32x16_bf16 v[88:103], v[116:119], v[112:115], v[88:103]
    ds_read_b128 v[112:115], v244 offset:768
    ds_read_b128 v[116:119], v48 offset:768
    s_waitcnt lgkmcnt(6)
    v_mfma_f32_32x32x16_bf16 v[72:87], a[228:231], v[120:123], v[72:87]
    v_mfma_f32_32x32x16_bf16 v[88:103], v[124:127], v[120:123], v[88:103]
    ds_read_b128 v[120:123], v245 offset:768
    ds_read_b128 v[124:127], v49 offset:768
    s_waitcnt lgkmcnt(6)
    v_mfma_f32_32x32x16_bf16 v[72:87], a[232:235], v[128:131], v[72:87]
    v_mfma_f32_32x32x16_bf16 v[88:103], v[132:135], v[128:131], v[88:103]
    ds_read_b128 v[128:131], v246 offset:768
    ds_read_b128 v[132:135], v50 offset:768
    s_waitcnt lgkmcnt(6)
    v_mfma_f32_32x32x16_bf16 v[72:87], a[236:239], v[136:139], v[72:87]
    v_mfma_f32_32x32x16_bf16 v[88:103], v[140:143], v[136:139], v[88:103]
    ds_read_b128 v[136:139], v247 offset:768
    ds_read_b128 v[140:143], v51 offset:768
    s_waitcnt lgkmcnt(6)
    v_mfma_f32_32x32x16_bf16 v[72:87], a[240:243], v[112:115], v[72:87]
    v_mfma_f32_32x32x16_bf16 v[88:103], v[116:119], v[112:115], v[88:103]
    s_waitcnt lgkmcnt(4)
    v_mfma_f32_32x32x16_bf16 v[72:87], a[244:247], v[120:123], v[72:87]
    v_mfma_f32_32x32x16_bf16 v[88:103], v[124:127], v[120:123], v[88:103]
    s_waitcnt lgkmcnt(2)
    v_mfma_f32_32x32x16_bf16 v[72:87], a[248:251], v[128:131], v[72:87]
    v_mfma_f32_32x32x16_bf16 v[88:103], v[132:135], v[128:131], v[88:103]
    s_waitcnt lgkmcnt(0)
    v_mfma_f32_32x32x16_bf16 v[72:87], a[252:255], v[136:139], v[72:87]
    v_mfma_f32_32x32x16_bf16 v[88:103], v[140:143], v[136:139], v[88:103]
    s_barrier
    v_lshlrev_b32 v6, 4, v66
    v_add_u32 v6, 147456, v6
    s_lshl_b32 s3, s56, 2
    v_add_u32 v7, s3, v6
    s_nop 5
    v_max3_f32 v4, v72, v73, v74
    v_max3_f32 v4, v4, v75, v76
    v_max3_f32 v4, v4, v77, v78
    v_max3_f32 v4, v4, v79, v80
    v_max3_f32 v4, v4, v81, v82
    v_max3_f32 v4, v4, v83, v84
    v_max3_f32 v4, v4, v85, v86
    v_max3_f32 v4, v4, v87, v88
    v_max3_f32 v4, v4, v89, v90
    v_max3_f32 v4, v4, v91, v92
    v_max3_f32 v4, v4, v93, v94
    v_max3_f32 v4, v4, v95, v96
    v_max3_f32 v4, v4, v97, v98
    v_max3_f32 v4, v4, v99, v100
    v_max3_f32 v4, v4, v101, v102
    v_max_f32 v4, v4, v103
    v_mov_b32 v5, v4
    s_nop 1
    v_permlane32_swap_b32 v4, v5
    v_max_f32 v4, v4, v5
    ds_write_b32 v7, v4
    s_waitcnt lgkmcnt(0)
    s_barrier
    ds_read_b128 v[248:251], v6
    s_lshl_b32 s3, s56, 11
    s_add_u32 s3, s3, 131072
    v_add_u32 v8, s3, v22
    v_mov_b32 v5, s67
    buffer_load_dwordx4 v[208:211], v67, s[40:43], s55 offen nt
    s_add_u32 s55, s55, 0x2000
    buffer_load_dwordx4 v[212:215], v67, s[40:43], s55 offen nt
    s_add_u32 s55, s55, 0x2000
    buffer_load_dwordx4 v[216:219], v67, s[40:43], s55 offen nt
    s_add_u32 s55, s55, 0x2000
    buffer_load_dwordx4 v[220:223], v67, s[40:43], s55 offen nt
    s_add_u32 s55, s55, 0x2000
    buffer_load_dwordx4 v[224:227], v67, s[40:43], s55 offen nt
    s_add_u32 s55, s55, 0x2000
    buffer_load_dwordx4 v[228:231], v67, s[40:43], s55 offen nt
    s_add_u32 s55, s55, 0x2000
    buffer_load_dwordx4 v[232:235], v67, s[40:43], s55 offen nt
    s_add_u32 s55, s55, 0x2000
    buffer_load_dwordx4 v[236:239], v67, s[40:43], s55 offen nt
    s_waitcnt lgkmcnt(0)
    v_max3_f32 v4, v248, v249, v250
    v_max_f32 v4, v4, v251
    v_mul_f32 v4, s67, v4
    v_pk_fma_f32 v[72:73], v[72:73], v[4:5], v[4:5] op_sel:[0,1,0] op_sel_hi:[1,1,0] neg_lo:[0,0,1] neg_hi:[0,0,1]
    v_pk_fma_f32 v[74:75], v[74:75], v[4:5], v[4:5] op_sel:[0,1,0] op_sel_hi:[1,1,0] neg_lo:[0,0,1] neg_hi:[0,0,1]
    v_pk_fma_f32 v[76:77], v[76:77], v[4:5], v[4:5] op_sel:[0,1,0] op_sel_hi:[1,1,0] neg_lo:[0,0,1] neg_hi:[0,0,1]
    v_pk_fma_f32 v[78:79], v[78:79], v[4:5], v[4:5] op_sel:[0,1,0] op_sel_hi:[1,1,0] neg_lo:[0,0,1] neg_hi:[0,0,1]
    v_exp_f32 v72, v72
    v_exp_f32 v73, v73
    v_exp_f32 v74, v74
    v_exp_f32 v75, v75
    v_exp_f32 v76, v76
    v_exp_f32 v77, v77
    v_exp_f32 v78, v78
    v_exp_f32 v79, v79
    v_cvt_pk_bf16_f32 v112, v72, v73
    v_cvt_pk_bf16_f32 v113, v74, v75
    v_cvt_pk_bf16_f32 v114, v76, v77
    v_cvt_pk_bf16_f32 v115, v78, v79
    ds_write_b128 v8, v[112:115] offset:0
    v_pk_fma_f32 v[80:81], v[80:81], v[4:5], v[4:5] op_sel:[0,1,0] op_sel_hi:[1,1,0] neg_lo:[0,0,1] neg_hi:[0,0,1]
    v_pk_fma_f32 v[82:83], v[82:83], v[4:5], v[4:5] op_sel:[0,1,0] op_sel_hi:[1,1,0] neg_lo:[0,0,1] neg_hi:[0,0,1]
    v_pk_fma_f32 v[84:85], v[84:85], v[4:5], v[4:5] op_sel:[0,1,0] op_sel_hi:[1,1,0] neg_lo:[0,0,1] neg_hi:[0,0,1]
    v_pk_fma_f32 v[86:87], v[86:87], v[4:5], v[4:5] op_sel:[0,1,0] op_sel_hi:[1,1,0] neg_lo:[0,0,1] neg_hi:[0,0,1]
    v_exp_f32 v80, v80
    v_exp_f32 v81, v81
    v_exp_f32 v82, v82
    v_exp_f32 v83, v83
    v_exp_f32 v84, v84
    v_exp_f32 v85, v85
    v_exp_f32 v86, v86
    v_exp_f32 v87, v87
    v_cvt_pk_bf16_f32 v116, v80, v81
    v_cvt_pk_bf16_f32 v117, v82, v83
    v_cvt_pk_bf16_f32 v118, v84, v85
    v_cvt_pk_bf16_f32 v119, v86, v87
    ds_write_b128 v8, v[116:119] offset:1024
    v_pk_fma_f32 v[88:89], v[88:89], v[4:5], v[4:5] op_sel:[0,1,0] op_sel_hi:[1,1,0] neg_lo:[0,0,1] neg_hi:[0,0,1]
    v_pk_fma_f32 v[90:91], v[90:91], v[4:5], v[4:5] op_sel:[0,1,0] op_sel_hi:[1,1,0] neg_lo:[0,0,1] neg_hi:[0,0,1]
    v_pk_fma_f32 v[92:93], v[92:93], v[4:5], v[4:5] op_sel:[0,1,0] op_sel_hi:[1,1,0] neg_lo:[0,0,1] neg_hi:[0,0,1]
    v_pk_fma_f32 v[94:95], v[94:95], v[4:5], v[4:5] op_sel:[0,1,0] op_sel_hi:[1,1,0] neg_lo:[0,0,1] neg_hi:[0,0,1]
    v_exp_f32 v88, v88
    v_exp_f32 v89, v89
    v_exp_f32 v90, v90
    v_exp_f32 v91, v91
    v_exp_f32 v92, v92
    v_exp_f32 v93, v93
    v_exp_f32 v94, v94
    v_exp_f32 v95, v95
    v_cvt_pk_bf16_f32 v120, v88, v89
    v_cvt_pk_bf16_f32 v121, v90, v91
    v_cvt_pk_bf16_f32 v122, v92, v93
    v_cvt_pk_bf16_f32 v123, v94, v95
    ds_write_b128 v8, v[120:123] offset:8192
    v_pk_fma_f32 v[96:97], v[96:97], v[4:5], v[4:5] op_sel:[0,1,0] op_sel_hi:[1,1,0] neg_lo:[0,0,1] neg_hi:[0,0,1]
    v_pk_fma_f32 v[98:99], v[98:99], v[4:5], v[4:5] op_sel:[0,1,0] op_sel_hi:[1,1,0] neg_lo:[0,0,1] neg_hi:[0,0,1]
    v_pk_fma_f32 v[100:101], v[100:101], v[4:5], v[4:5] op_sel:[0,1,0] op_sel_hi:[1,1,0] neg_lo:[0,0,1] neg_hi:[0,0,1]
    v_pk_fma_f32 v[102:103], v[102:103], v[4:5], v[4:5] op_sel:[0,1,0] op_sel_hi:[1,1,0] neg_lo:[0,0,1] neg_hi:[0,0,1]
    v_exp_f32 v96, v96
    v_exp_f32 v97, v97
    v_exp_f32 v98, v98
    v_exp_f32 v99, v99
    v_exp_f32 v100, v100
    v_exp_f32 v101, v101
    v_exp_f32 v102, v102
    v_exp_f32 v103, v103
    v_cvt_pk_bf16_f32 v124, v96, v97
    v_cvt_pk_bf16_f32 v125, v98, v99
    v_cvt_pk_bf16_f32 v126, v100, v101
    v_cvt_pk_bf16_f32 v127, v102, v103
    ds_write_b128 v8, v[124:127] offset:9216
    v_pk_add_f32 v[72:73], v[72:73], v[88:89]
    v_pk_add_f32 v[74:75], v[74:75], v[90:91]
    v_pk_add_f32 v[76:77], v[76:77], v[92:93]
    v_pk_add_f32 v[78:79], v[78:79], v[94:95]
    v_pk_add_f32 v[80:81], v[80:81], v[96:97]
    v_pk_add_f32 v[82:83], v[82:83], v[98:99]
    v_pk_add_f32 v[84:85], v[84:85], v[100:101]
    v_pk_add_f32 v[86:87], v[86:87], v[102:103]
    v_pk_add_f32 v[72:73], v[72:73], v[80:81]
    v_pk_add_f32 v[74:75], v[74:75], v[82:83]
    v_pk_add_f32 v[76:77], v[76:77], v[84:85]
    v_pk_add_f32 v[78:79], v[78:79], v[86:87]
    v_pk_add_f32 v[72:73], v[72:73], v[76:77]
    v_pk_add_f32 v[74:75], v[74:75], v[78:79]
    v_pk_add_f32 v[72:73], v[72:73], v[74:75]
    v_add_f32 v64, v72, v73
    v_mov_b32 v63, v4
    v_mov_b32 v5, v64
    v_add_u32 v8, 131072, v22
    s_nop 0
    v_permlane32_swap_b32 v5, v64
    v_add_f32 v5, v5, v64
    ds_write_b32 v7, v5 offset:1024
    s_waitcnt lgkmcnt(0)
    s_barrier
    ds_read_b128 a[128:131], v8 offset:0
    ds_read_b128 a[160:163], v8 offset:8192
    ds_read_b64_tr_b16 v[72:73], v52 offset:0
    ds_read_b64_tr_b16 v[74:75], v53 offset:0
    ds_read_b128 a[132:135], v8 offset:1024
    ds_read_b128 a[164:167], v8 offset:9216
    ds_read_b64_tr_b16 v[76:77], v52 offset:16384
    ds_read_b64_tr_b16 v[78:79], v53 offset:16384
    ds_read_b128 a[136:139], v8 offset:2048
    ds_read_b128 a[168:171], v8 offset:10240
    ds_read_b64_tr_b16 v[80:81], v52 offset:32768
    ds_read_b64_tr_b16 v[82:83], v53 offset:32768
    ds_read_b128 v[252:255], v6 offset:1024
    s_waitcnt lgkmcnt(12)
    v_mfma_f32_32x32x16_bf16 v[112:127], a[0:3], a[128:131], 0
    ds_read_b128 a[140:143], v8 offset:3072
    ds_read_b128 a[172:175], v8 offset:11264
    ds_read_b64_tr_b16 v[84:85], v52 offset:49152
    ds_read_b64_tr_b16 v[86:87], v53 offset:49152
    v_and_b32 v4, 3, v1
    v_bfe_u32 v5, v1, 2, 2
    s_waitcnt lgkmcnt(13)
    v_mfma_f32_32x32x16_bf16 v[112:127], v[72:75], a[160:163], v[112:127]
    v_lshl_add_u32 v4, v4, 2, v5
    v_lshlrev_b32 v5, 10, v66
    s_waitcnt lgkmcnt(12)
    v_mfma_f32_32x32x16_bf16 v[112:127], a[16:19], a[132:135], v[112:127]
    ds_read_b128 a[144:147], v8 offset:4096
    ds_read_b128 a[176:179], v8 offset:12288
    ds_read_b64_tr_b16 v[72:73], v104 offset:0
    ds_read_b64_tr_b16 v[74:75], v105 offset:0
    v_lshl_add_u32 v5, v65, 3, v5
    v_lshl_add_u32 v4, v4, 4, v5
    s_waitcnt lgkmcnt(13)
    v_mfma_f32_32x32x16_bf16 v[112:127], v[76:79], a[164:167], v[112:127]
    v_add_u32 v60, s63, v4
    v_mov_b32 v248, v63
    s_waitcnt lgkmcnt(12)
    v_mfma_f32_32x32x16_bf16 v[112:127], a[32:35], a[136:139], v[112:127]
    ds_read_b128 a[148:151], v8 offset:5120
    ds_read_b128 a[180:183], v8 offset:13312
    ds_read_b64_tr_b16 v[76:77], v104 offset:16384
    ds_read_b64_tr_b16 v[78:79], v105 offset:16384
    v_mov_b32 v250, s60
    v_mov_b32 v251, s60
    s_waitcnt lgkmcnt(13)
    v_mfma_f32_32x32x16_bf16 v[112:127], v[80:83], a[168:171], v[112:127]
    v_lshlrev_b32 v6, 7, v66
    s_lshr_b32 s3, s69, 3
    s_lshl_b32 s3, s3, 8
    s_waitcnt lgkmcnt(11)
    v_mfma_f32_32x32x16_bf16 v[112:127], a[48:51], a[140:143], v[112:127]
    ds_read_b128 a[152:155], v8 offset:6144
    ds_read_b128 a[184:187], v8 offset:14336
    ds_read_b64_tr_b16 v[80:81], v104 offset:32768
    ds_read_b64_tr_b16 v[82:83], v105 offset:32768
    s_and_b32 s62, s69, 7
    s_add_u32 s3, s3, s62
    s_lshl_b32 s3, s3, 4
    s_add_u32 s62, s3, 393216
    s_waitcnt lgkmcnt(12)
    v_mfma_f32_32x32x16_bf16 v[112:127], v[84:87], a[172:175], v[112:127]
    s_waitcnt lgkmcnt(11)
    v_mfma_f32_32x32x16_bf16 v[112:127], a[64:67], a[144:147], v[112:127]
    ds_read_b128 a[156:159], v8 offset:7168
    ds_read_b128 a[188:191], v8 offset:15360
    ds_read_b64_tr_b16 v[84:85], v104 offset:49152
    ds_read_b64_tr_b16 v[86:87], v105 offset:49152
    v_add_f32 v249, v252, v253
    v_add_f32 v254, v254, v255
    s_waitcnt lgkmcnt(12)
    v_mfma_f32_32x32x16_bf16 v[112:127], v[72:75], a[176:179], v[112:127]
    v_add_f32 v249, v249, v254
    s_cmp_lg_u32 s56, 0
    s_cbranch_scc1 L_nostat_73
    s_mov_b32 exec_hi, 0
    s_cmp_eq_u32 s0, 0
    s_cbranch_scc1 L_far_74
    buffer_store_dwordx4 v[248:251], v6, s[48:51], s62 offen
    s_branch L_join_75
L_far_74:
    buffer_store_dwordx4 v[248:251], v6, s[48:51], s62 offen sc1
L_join_75:
    s_nop 1
    s_mov_b64 exec, -1
L_nostat_73:
    s_waitcnt lgkmcnt(11)
    v_mfma_f32_32x32x16_bf16 v[112:127], a[80:83], a[148:151], v[112:127]
    ds_read_b64_tr_b16 v[72:73], v54 offset:0
    ds_read_b64_tr_b16 v[74:75], v55 offset:0
    s_waitcnt lgkmcnt(10)
    v_mfma_f32_32x32x16_bf16 v[112:127], v[76:79], a[180:183], v[112:127]
    s_waitcnt lgkmcnt(9)
    v_mfma_f32_32x32x16_bf16 v[112:127], a[96:99], a[152:155], v[112:127]
    ds_read_b64_tr_b16 v[76:77], v54 offset:16384
    ds_read_b64_tr_b16 v[78:79], v55 offset:16384
    s_waitcnt lgkmcnt(8)
    v_mfma_f32_32x32x16_bf16 v[112:127], v[80:83], a[184:187], v[112:127]
    s_waitcnt lgkmcnt(7)
    v_mfma_f32_32x32x16_bf16 v[112:127], a[112:115], a[156:159], v[112:127]
    ds_read_b64_tr_b16 v[80:81], v54 offset:32768
    ds_read_b64_tr_b16 v[82:83], v55 offset:32768
    s_waitcnt lgkmcnt(6)
    v_mfma_f32_32x32x16_bf16 v[112:127], v[84:87], a[188:191], v[112:127]
    v_mfma_f32_32x32x16_bf16 v[128:143], a[4:7], a[128:131], 0
    ds_read_b64_tr_b16 v[84:85], v54 offset:49152
    ds_read_b64_tr_b16 v[86:87], v55 offset:49152
    s_waitcnt lgkmcnt(6)
    v_mfma_f32_32x32x16_bf16 v[128:143], v[72:75], a[160:163], v[128:143]
    v_mfma_f32_32x32x16_bf16 v[128:143], a[20:23], a[132:135], v[128:143]
    ds_read_b64_tr_b16 v[72:73], v106 offset:0
    ds_read_b64_tr_b16 v[74:75], v107 offset:0
    s_waitcnt lgkmcnt(6)
    v_mfma_f32_32x32x16_bf16 v[128:143], v[76:79], a[164:167], v[128:143]
    s_nop 1
    v_cvt_pk_bf16_f32 v112, v112, v113
    v_cvt_pk_bf16_f32 v113, v114, v115
    v_mfma_f32_32x32x16_bf16 v[128:143], a[36:39], a[136:139], v[128:143]
    ds_read_b64_tr_b16 v[76:77], v106 offset:16384
    ds_read_b64_tr_b16 v[78:79], v107 offset:16384
    v_xor_b32 v114, 0, v60
    ds_write_b64 v114, v[112:113]
    s_waitcnt lgkmcnt(7)
    v_mfma_f32_32x32x16_bf16 v[128:143], v[80:83], a[168:171], v[128:143]
    v_cvt_pk_bf16_f32 v116, v116, v117
    v_cvt_pk_bf16_f32 v117, v118, v119
    v_mfma_f32_32x32x16_bf16 v[128:143], a[52:55], a[140:143], v[128:143]
    ds_read_b64_tr_b16 v[80:81], v106 offset:32768
    ds_read_b64_tr_b16 v[82:83], v107 offset:32768
    v_xor_b32 v118, 16, v60
    ds_write_b64 v118, v[116:117]
    s_waitcnt lgkmcnt(8)
    v_mfma_f32_32x32x16_bf16 v[128:143], v[84:87], a[172:175], v[128:143]
    v_cvt_pk_bf16_f32 v120, v120, v121
    v_cvt_pk_bf16_f32 v121, v122, v123
    v_mfma_f32_32x32x16_bf16 v[128:143], a[68:71], a[144:147], v[128:143]
    ds_read_b64_tr_b16 v[84:85], v106 offset:49152
    ds_read_b64_tr_b16 v[86:87], v107 offset:49152
    v_xor_b32 v122, 32, v60
    ds_write_b64 v122, v[120:121]
    s_waitcnt lgkmcnt(9)
    v_mfma_f32_32x32x16_bf16 v[128:143], v[72:75], a[176:179], v[128:143]
    v_cvt_pk_bf16_f32 v124, v124, v125
    v_cvt_pk_bf16_f32 v125, v126, v127
    v_mfma_f32_32x32x16_bf16 v[128:143], a[84:87], a[148:151], v[128:143]
    ds_read_b64_tr_b16 v[72:73], v56 offset:0
    ds_read_b64_tr_b16 v[74:75], v57 offset:0
    v_xor_b32 v126, 48, v60
    ds_write_b64 v126, v[124:125]
    s_waitcnt lgkmcnt(10)
    v_mfma_f32_32x32x16_bf16 v[128:143], v[76:79], a[180:183], v[128:143]
    v_mfma_f32_32x32x16_bf16 v[128:143], a[100:103], a[152:155], v[128:143]
    ds_read_b64_tr_b16 v[76:77], v56 offset:16384
    ds_read_b64_tr_b16 v[78:79], v57 offset:16384
    s_waitcnt lgkmcnt(9)
    v_mfma_f32_32x32x16_bf16 v[128:143], v[80:83], a[184:187], v[128:143]
    v_mfma_f32_32x32x16_bf16 v[128:143], a[116:119], a[156:159], v[128:143]
    ds_read_b64_tr_b16 v[80:81], v56 offset:32768
    ds_read_b64_tr_b16 v[82:83], v57 offset:32768
    s_waitcnt lgkmcnt(8)
    v_mfma_f32_32x32x16_bf16 v[128:143], v[84:87], a[188:191], v[128:143]
    v_mfma_f32_32x32x16_bf16 v[144:159], a[8:11], a[128:131], 0
    ds_read_b64_tr_b16 v[84:85], v56 offset:49152
    ds_read_b64_tr_b16 v[86:87], v57 offset:49152
    s_waitcnt lgkmcnt(7)
    v_mfma_f32_32x32x16_bf16 v[144:159], v[72:75], a[160:163], v[144:159]
    v_mfma_f32_32x32x16_bf16 v[144:159], a[24:27], a[132:135], v[144:159]
    ds_read_b64_tr_b16 v[72:73], v108 offset:0
    ds_read_b64_tr_b16 v[74:75], v109 offset:0
    s_waitcnt lgkmcnt(6)
    v_mfma_f32_32x32x16_bf16 v[144:159], v[76:79], a[164:167], v[144:159]
    s_nop 1
    v_cvt_pk_bf16_f32 v128, v128, v129
    v_cvt_pk_bf16_f32 v129, v130, v131
    v_mfma_f32_32x32x16_bf16 v[144:159], a[40:43], a[136:139], v[144:159]
    ds_read_b64_tr_b16 v[76:77], v108 offset:16384
    ds_read_b64_tr_b16 v[78:79], v109 offset:16384
    v_xor_b32 v130, 64, v60
    ds_write_b64 v130, v[128:129]
    s_waitcnt lgkmcnt(7)
    v_mfma_f32_32x32x16_bf16 v[144:159], v[80:83], a[168:171], v[144:159]
    v_cvt_pk_bf16_f32 v132, v132, v133
    v_cvt_pk_bf16_f32 v133, v134, v135
    v_mfma_f32_32x32x16_bf16 v[144:159], a[56:59], a[140:143], v[144:159]
    ds_read_b64_tr_b16 v[80:81], v108 offset:32768
    ds_read_b64_tr_b16 v[82:83], v109 offset:32768
    v_xor_b32 v134, 80, v60
    ds_write_b64 v134, v[132:133]
    s_waitcnt lgkmcnt(8)
    v_mfma_f32_32x32x16_bf16 v[144:159], v[84:87], a[172:175], v[144:159]
    v_cvt_pk_bf16_f32 v136, v136, v137
    v_cvt_pk_bf16_f32 v137, v138, v139
    v_mfma_f32_32x32x16_bf16 v[144:159], a[72:75], a[144:147], v[144:159]
    ds_read_b64_tr_b16 v[84:85], v108 offset:49152
    ds_read_b64_tr_b16 v[86:87], v109 offset:49152
    v_xor_b32 v138, 96, v60
    ds_write_b64 v138, v[136:137]
    s_waitcnt lgkmcnt(9)
    v_mfma_f32_32x32x16_bf16 v[144:159], v[72:75], a[176:179], v[144:159]
    v_cvt_pk_bf16_f32 v140, v140, v141
    v_cvt_pk_bf16_f32 v141, v142, v143
    v_mfma_f32_32x32x16_bf16 v[144:159], a[88:91], a[148:151], v[144:159]
    ds_read_b64_tr_b16 v[72:73], v58 offset:0
    ds_read_b64_tr_b16 v[74:75], v59 offset:0
    v_xor_b32 v142, 112, v60
    ds_write_b64 v142, v[140:141]
    s_waitcnt lgkmcnt(10)
    v_mfma_f32_32x32x16_bf16 v[144:159], v[76:79], a[180:183], v[144:159]
    v_mfma_f32_32x32x16_bf16 v[144:159], a[104:107], a[152:155], v[144:159]
    ds_read_b64_tr_b16 v[76:77], v58 offset:16384
    ds_read_b64_tr_b16 v[78:79], v59 offset:16384
    s_waitcnt lgkmcnt(9)
    v_mfma_f32_32x32x16_bf16 v[144:159], v[80:83], a[184:187], v[144:159]
    v_mfma_f32_32x32x16_bf16 v[144:159], a[120:123], a[156:159], v[144:159]
    ds_read_b64_tr_b16 v[80:81], v58 offset:32768
    ds_read_b64_tr_b16 v[82:83], v59 offset:32768
    s_waitcnt lgkmcnt(8)
    v_mfma_f32_32x32x16_bf16 v[144:159], v[84:87], a[188:191], v[144:159]
    v_mfma_f32_32x32x16_bf16 v[160:175], a[12:15], a[128:131], 0
    ds_read_b64_tr_b16 v[84:85], v58 offset:49152
    ds_read_b64_tr_b16 v[86:87], v59 offset:49152
    s_waitcnt lgkmcnt(7)
    v_mfma_f32_32x32x16_bf16 v[160:175], v[72:75], a[160:163], v[160:175]
    v_mfma_f32_32x32x16_bf16 v[160:175], a[28:31], a[132:135], v[160:175]
    ds_read_b64_tr_b16 v[72:73], v110 offset:0
    ds_read_b64_tr_b16 v[74:75], v111 offset:0
    s_waitcnt lgkmcnt(6)
    v_mfma_f32_32x32x16_bf16 v[160:175], v[76:79], a[164:167], v[160:175]
    s_nop 1
    v_cvt_pk_bf16_f32 v144, v144, v145
    v_cvt_pk_bf16_f32 v145, v146, v147
    v_mfma_f32_32x32x16_bf16 v[160:175], a[44:47], a[136:139], v[160:175]
    ds_read_b64_tr_b16 v[76:77], v110 offset:16384
    ds_read_b64_tr_b16 v[78:79], v111 offset:16384
    v_xor_b32 v146, 128, v60
    ds_write_b64 v146, v[144:145]
    s_waitcnt lgkmcnt(7)
    v_mfma_f32_32x32x16_bf16 v[160:175], v[80:83], a[168:171], v[160:175]
    v_cvt_pk_bf16_f32 v148, v148, v149
    v_cvt_pk_bf16_f32 v149, v150, v151
    v_mfma_f32_32x32x16_bf16 v[160:175], a[60:63], a[140:143], v[160:175]
    ds_read_b64_tr_b16 v[80:81], v110 offset:32768
    ds_read_b64_tr_b16 v[82:83], v111 offset:32768
    v_xor_b32 v150, 144, v60
    ds_write_b64 v150, v[148:149]
    s_waitcnt lgkmcnt(8)
    v_mfma_f32_32x32x16_bf16 v[160:175], v[84:87], a[172:175], v[160:175]
    v_cvt_pk_bf16_f32 v152, v152, v153
    v_cvt_pk_bf16_f32 v153, v154, v155
    v_mfma_f32_32x32x16_bf16 v[160:175], a[76:79], a[144:147], v[160:175]
    ds_read_b64_tr_b16 v[84:85], v110 offset:49152
    ds_read_b64_tr_b16 v[86:87], v111 offset:49152
    v_xor_b32 v154, 160, v60
    ds_write_b64 v154, v[152:153]
    s_waitcnt lgkmcnt(9)
    v_mfma_f32_32x32x16_bf16 v[160:175], v[72:75], a[176:179], v[160:175]
    v_cvt_pk_bf16_f32 v156, v156, v157
    v_cvt_pk_bf16_f32 v157, v158, v159
    v_mfma_f32_32x32x16_bf16 v[160:175], a[92:95], a[148:151], v[160:175]
    v_xor_b32 v158, 176, v60
    ds_write_b64 v158, v[156:157]
    s_waitcnt lgkmcnt(8)
    v_mfma_f32_32x32x16_bf16 v[160:175], v[76:79], a[180:183], v[160:175]
    v_mfma_f32_32x32x16_bf16 v[160:175], a[108:111], a[152:155], v[160:175]
    s_waitcnt lgkmcnt(5)
    v_mfma_f32_32x32x16_bf16 v[160:175], v[80:83], a[184:187], v[160:175]
    v_mfma_f32_32x32x16_bf16 v[160:175], a[124:127], a[156:159], v[160:175]
    s_waitcnt lgkmcnt(2)
    v_mfma_f32_32x32x16_bf16 v[160:175], v[84:87], a[188:191], v[160:175]
    s_lshl_b32 s59, s69, 2
    s_add_u32 s59, s59, s56
    s_lshl_b32 s3, s59, 7
    s_add_u32 s68, s3, 393216
    v_and_b32 v5, 1, v2
    v_lshl_add_u32 v5, v5, 2, v3
    v_lshlrev_b32 v5, 4, v5
    v_lshlrev_b32 v4, 2, v3
    v_xor_b32 v4, v4, v2
    v_lshlrev_b32 v7, 10, v3
    v_lshl_add_u32 v7, v4, 4, v7
    v_add_u32 v44, s63, v7
    v_xor_b32 v45, 16, v44
    v_xor_b32 v46, 32, v44
    v_xor_b32 v47, 48, v44
    v_cvt_pk_bf16_f32 v160, v160, v161
    v_cvt_pk_bf16_f32 v161, v162, v163
    v_xor_b32 v162, 192, v60
    ds_write_b64 v162, v[160:161]
    v_cvt_pk_bf16_f32 v164, v164, v165
    v_cvt_pk_bf16_f32 v165, v166, v167
    v_xor_b32 v166, 208, v60
    ds_write_b64 v166, v[164:165]
    v_cvt_pk_bf16_f32 v168, v168, v169
    v_cvt_pk_bf16_f32 v169, v170, v171
    v_xor_b32 v170, 224, v60
    ds_write_b64 v170, v[168:169]
    v_cvt_pk_bf16_f32 v172, v172, v173
    v_cvt_pk_bf16_f32 v173, v174, v175
    v_xor_b32 v174, 240, v60
    ds_write_b64 v174, v[172:173]
    ds_read_b128 v[72:75], v44 offset:0
    ds_read_b128 v[76:79], v45 offset:4096
    ds_read_b128 v[80:83], v46 offset:8192
    ds_read_b128 v[84:87], v47 offset:12288
    ds_read_b128 v[88:91], v44 offset:16384
    ds_read_b128 v[92:95], v45 offset:20480
    ds_read_b128 v[96:99], v46 offset:24576
    ds_read_b128 v[100:103], v47 offset:28672
    s_lshr_b32 s53, s69, 3
    s_lshl_b32 s52, s53, 7
    s_add_u32 s52, s52, s56
    s_and_b32 s3, s69, 7
    s_lshl3_add_u32 s52, s52, s3
    s_lshl_b32 s52, s52, 8
    s_add_u32 s52, s52, 2097152
    s_mul_i32 s54, s3, 11
    s_lshr_b32 s54, s54, 5
    s_lshl_b32 s53, s53, 11
    s_add_u32 s53, s53, 360448
    v_lshlrev_b32 v48, 13, v3
    v_lshl_add_u32 v48, v2, 4, v48
    s_and_b32 s3, s59, 31
    s_lshl_b32 s3, s3, 3
    v_mov_b32 v49, s3
    v_mov_b32 v8, s60
    v_not_b32 v250, v8
    buffer_load_dwordx4 v[248:251], v5, s[48:51], s68 offen sc1
    s_cmp_eq_u32 s0, 0
    s_cbranch_scc1 L_far_76
    s_waitcnt lgkmcnt(7)
    s_add_u32 s3, s52, 0
    buffer_store_dwordx4 v[72:75], v48, s[48:51], s3 offen
    s_waitcnt lgkmcnt(6)
    s_add_u32 s3, s52, 32768
    buffer_store_dwordx4 v[76:79], v48, s[48:51], s3 offen
    s_waitcnt lgkmcnt(5)
    s_add_u32 s3, s52, 65536
    buffer_store_dwordx4 v[80:83], v48, s[48:51], s3 offen
    s_branch L_join_77
L_far_76:
    s_waitcnt lgkmcnt(7)
    s_add_u32 s3, s52, 0
    buffer_store_dwordx4 v[72:75], v48, s[48:51], s3 offen sc1
    s_waitcnt lgkmcnt(6)
    s_add_u32 s3, s52, 32768
    buffer_store_dwordx4 v[76:79], v48, s[48:51], s3 offen sc1
    s_waitcnt lgkmcnt(5)
    s_add_u32 s3, s52, 65536
    buffer_store_dwordx4 v[80:83], v48, s[48:51], s3 offen sc1
L_join_77:
    s_mul_i32 s3, s54, 12
    s_sub_u32 s61, s59, s3
    s_lshl_b32 s61, s61, 13
    s_add_u32 s61, s61, 2097152
    s_waitcnt vmcnt(3)
L_chk_78:
    v_xor_b32 v4, s60, v250
    v_bitop3_b32 v4, v4, v251, s60 bitop3:0xf6
    v_cmp_ne_u32 vcc, 0, v4
    s_cbranch_vccz L_ok_79
    s_cmp_eq_u32 s64, 0
    s_cbranch_scc1 L_ok_79
    s_sub_u32 s64, s64, 1
    buffer_load_dwordx4 v[248:251], v5, s[48:51], s68 offen sc1
    s_waitcnt vmcnt(0)
    s_branch L_chk_78
L_ok_79:
    s_add_u32 s68, s61, 0x1000
    v_max_f32_dpp v252, v248, v248 quad_perm:[1,0,3,2] row_mask:0xf bank_mask:0xf
    v_mov_b32 v6, v252
    s_nop 1
    v_permlane16_swap_b32 v6, v252
    v_max_f32 v252, v252, v6
    v_mov_b32 v6, v252
    s_nop 1
    v_permlane32_swap_b32 v6, v252
    v_max_f32 v252, v252, v6
    v_sub_f32 v5, v248, v252
    v_exp_f32 v5, v5
    s_nop 0
    v_mul_f32 v253, v5, v249
    s_nop 1
    v_add_f32_dpp v253, v253, v253 quad_perm:[1,0,3,2] row_mask:0xf bank_mask:0xf
    v_mov_b32 v6, v253
    s_nop 1
    v_permlane16_swap_b32 v6, v253
    v_add_f32 v253, v253, v6
    v_mov_b32 v6, v253
    s_nop 1
    v_permlane32_swap_b32 v6, v253
    v_add_f32 v253, v253, v6
    v_cvt_pk_bf16_f32 v248, v5, v5
    v_mov_b32 v254, s60
    v_mov_b32 v255, s60
    s_and_b32 s3, s59, 31
    s_lshl_b32 s3, s3, 5
    s_lshr_b32 s62, s69, 3
    s_add_u32 s3, s3, s62
    s_lshl_b32 s3, s3, 4
    s_add_u32 s3, s3, 327680
    v_mov_b32 v6, s3
    s_and_b32 s3, s59, 31
    s_mul_i32 s3, s3, 8192
    s_mul_i32 s59, s62, 256
    s_add_u32 s3, s3, s59
    s_add_u32 s59, s3, 1048576
    v_mul_u32_u24 v7, 2048, v3
    v_lshl_add_u32 v7, v2, 4, v7
    s_waitcnt vmcnt(0) lgkmcnt(0)
    s_cmp_eq_u32 s0, 0
    s_cbranch_scc1 L_far_80
    s_mov_b64 exec, 1
    buffer_store_dwordx2 v[8:9], v49, s[48:51], s53 offen offset:0
    s_mov_b64 exec, -1
    s_branch L_join_81
L_far_80:
    s_mov_b64 exec, 1
    buffer_store_dwordx2 v[8:9], v49, s[48:51], s53 offen offset:0 sc1
    s_mov_b64 exec, -1
L_join_81:
    v_and_b32_dpp v24, v248, v10 row_newbcast:0 row_mask:0xf bank_mask:0xf
    v_and_b32_dpp v25, v248, v11 row_newbcast:0 row_mask:0xf bank_mask:0xf
    v_and_b32_dpp v26, v248, v12 row_newbcast:0 row_mask:0xf bank_mask:0xf
    v_and_b32_dpp v27, v248, v13 row_newbcast:0 row_mask:0xf bank_mask:0xf
    v_and_b32_dpp v28, v248, v10 row_newbcast:1 row_mask:0xf bank_mask:0xf
    v_and_b32_dpp v29, v248, v11 row_newbcast:1 row_mask:0xf bank_mask:0xf
    v_and_b32_dpp v30, v248, v12 row_newbcast:1 row_mask:0xf bank_mask:0xf
    v_and_b32_dpp v31, v248, v13 row_newbcast:1 row_mask:0xf bank_mask:0xf
    s_cmp_lg_u32 s54, 0
    s_cbranch_scc1 L_other_82
    v_lshlrev_b32 v50, 3, v66
    buffer_load_dwordx2 v[240:241], v50, s[48:51], s53 offen offset:0 sc1
    s_waitcnt vmcnt(0)
L_chk_83:
    v_xor_b32 v4, s60, v240
    v_bitop3_b32 v4, v4, v241, s60 bitop3:0xf6
    v_cmp_ne_u32 vcc, 0, v4
    s_cbranch_vccz L_ok_84
    s_cmp_eq_u32 s64, 0
    s_cbranch_scc1 L_ok_84
    s_sub_u32 s64, s64, 1
    buffer_load_dwordx2 v[240:241], v50, s[48:51], s53 offen offset:0 sc1
    s_waitcnt vmcnt(0)
    s_branch L_chk_83
L_ok_84:
    buffer_load_dwordx4 v[128:131], v22, s[48:51], s61 offen offset:0 sc1
    buffer_load_dwordx4 v[132:135], v22, s[48:51], s61 offen offset:1024 sc1
    buffer_load_dwordx4 v[136:139], v22, s[48:51], s61 offen offset:2048 sc1
    buffer_load_dwordx4 v[140:143], v22, s[48:51], s61 offen offset:3072 sc1
    buffer_load_dwordx4 v[144:147], v22, s[48:51], s68 offen offset:0 sc1
    buffer_load_dwordx4 v[148:151], v22, s[48:51], s68 offen offset:1024 sc1
    buffer_load_dwordx4 v[152:155], v22, s[48:51], s68 offen offset:2048 sc1
    buffer_load_dwordx4 v[156:159], v22, s[48:51], s68 offen offset:3072 sc1
    s_waitcnt vmcnt(0)
    s_cmp_eq_u32 s0, 0
    s_cbranch_scc1 L_far_85
    s_mov_b64 exec, 1
    buffer_store_dwordx2 v[8:9], v49, s[48:51], s53 offen offset:256
    s_mov_b64 exec, -1
    s_branch L_join_86
L_far_85:
    s_mov_b64 exec, 1
    buffer_store_dwordx2 v[8:9], v49, s[48:51], s53 offen offset:256 sc1
    s_mov_b64 exec, -1
L_join_86:
L_other_82:
    v_min_u32 v50, 11, v1
    v_add_u32 v50, 0, v50
    v_lshlrev_b32 v50, 3, v50
    buffer_load_dwordx2 v[240:241], v50, s[48:51], s53 offen offset:256 sc1
    s_waitcnt vmcnt(0)
L_chk_87:
    v_xor_b32 v4, s60, v240
    v_bitop3_b32 v4, v4, v241, s60 bitop3:0xf6
    v_cmp_ne_u32 vcc, 0, v4
    s_cbranch_vccz L_ok_88
    s_cmp_eq_u32 s64, 0
    s_cbranch_scc1 L_ok_88
    s_sub_u32 s64, s64, 1
    buffer_load_dwordx2 v[240:241], v50, s[48:51], s53 offen offset:256 sc1
    s_waitcnt vmcnt(0)
    s_branch L_chk_87
L_ok_88:
    s_cmp_eq_u32 s0, 0
    s_cbranch_scc1 L_far_89
    s_add_u32 s3, s52, 0
    buffer_store_dwordx4 v[84:87], v48, s[48:51], s3 offen
    s_add_u32 s3, s52, 32768
    buffer_store_dwordx4 v[88:91], v48, s[48:51], s3 offen
    s_add_u32 s3, s52, 65536
    buffer_store_dwordx4 v[92:95], v48, s[48:51], s3 offen
    s_waitcnt vmcnt(0)
    s_mov_b64 exec, 1
    buffer_store_dwordx2 v[8:9], v49, s[48:51], s53 offen offset:512
    s_mov_b64 exec, -1
    s_branch L_join_90
L_far_89:
    s_add_u32 s3, s52, 0
    buffer_store_dwordx4 v[84:87], v48, s[48:51], s3 offen sc1
    s_add_u32 s3, s52, 32768
    buffer_store_dwordx4 v[88:91], v48, s[48:51], s3 offen sc1
    s_add_u32 s3, s52, 65536
    buffer_store_dwordx4 v[92:95], v48, s[48:51], s3 offen sc1
    s_waitcnt vmcnt(0)
    s_mov_b64 exec, 1
    buffer_store_dwordx2 v[8:9], v49, s[48:51], s53 offen offset:512 sc1
    s_mov_b64 exec, -1
L_join_90:
    s_cmp_lg_u32 s54, 1
    s_cbranch_scc1 L_other_91
    v_lshlrev_b32 v50, 3, v66
    buffer_load_dwordx2 v[240:241], v50, s[48:51], s53 offen offset:512 sc1
    s_waitcnt vmcnt(0)
L_chk_92:
    v_xor_b32 v4, s60, v240
    v_bitop3_b32 v4, v4, v241, s60 bitop3:0xf6
    v_cmp_ne_u32 vcc, 0, v4
    s_cbranch_vccz L_ok_93
    s_cmp_eq_u32 s64, 0
    s_cbranch_scc1 L_ok_93
    s_sub_u32 s64, s64, 1
    buffer_load_dwordx2 v[240:241], v50, s[48:51], s53 offen offset:512 sc1
    s_waitcnt vmcnt(0)
    s_branch L_chk_92
L_ok_93:
    buffer_load_dwordx4 v[128:131], v22, s[48:51], s61 offen offset:0 sc1
    buffer_load_dwordx4 v[132:135], v22, s[48:51], s61 offen offset:1024 sc1
    buffer_load_dwordx4 v[136:139], v22, s[48:51], s61 offen offset:2048 sc1
    buffer_load_dwordx4 v[140:143], v22, s[48:51], s61 offen offset:3072 sc1
    buffer_load_dwordx4 v[144:147], v22, s[48:51], s68 offen offset:0 sc1
    buffer_load_dwordx4 v[148:151], v22, s[48:51], s68 offen offset:1024 sc1
    buffer_load_dwordx4 v[152:155], v22, s[48:51], s68 offen offset:2048 sc1
    buffer_load_dwordx4 v[156:159], v22, s[48:51], s68 offen offset:3072 sc1
    s_waitcnt vmcnt(0)
    s_cmp_eq_u32 s0, 0
    s_cbranch_scc1 L_far_94
    s_mov_b64 exec, 1
    buffer_store_dwordx2 v[8:9], v49, s[48:51], s53 offen offset:768
    s_mov_b64 exec, -1
    s_branch L_join_95
L_far_94:
    s_mov_b64 exec, 1
    buffer_store_dwordx2 v[8:9], v49, s[48:51], s53 offen offset:768 sc1
    s_mov_b64 exec, -1
L_join_95:
L_other_91:
    v_min_u32 v50, 11, v1
    v_add_u32 v50, 12, v50
    v_lshlrev_b32 v50, 3, v50
    buffer_load_dwordx2 v[240:241], v50, s[48:51], s53 offen offset:768 sc1
    s_waitcnt vmcnt(0)
L_chk_96:
    v_xor_b32 v4, s60, v240
    v_bitop3_b32 v4, v4, v241, s60 bitop3:0xf6
    v_cmp_ne_u32 vcc, 0, v4
    s_cbranch_vccz L_ok_97
    s_cmp_eq_u32 s64, 0
    s_cbranch_scc1 L_ok_97
    s_sub_u32 s64, s64, 1
    buffer_load_dwordx2 v[240:241], v50, s[48:51], s53 offen offset:768 sc1
    s_waitcnt vmcnt(0)
    s_branch L_chk_96
L_ok_97:
    s_cmp_eq_u32 s0, 0
    s_cbranch_scc1 L_far_98
    s_add_u32 s3, s52, 0
    buffer_store_dwordx4 v[96:99], v48, s[48:51], s3 offen
    s_add_u32 s3, s52, 32768
    buffer_store_dwordx4 v[100:103], v48, s[48:51], s3 offen
    s_waitcnt vmcnt(0)
    s_mov_b64 exec, 1
    buffer_store_dwordx2 v[8:9], v49, s[48:51], s53 offen offset:1024
    s_mov_b64 exec, -1
    s_branch L_join_99
L_far_98:
    s_add_u32 s3, s52, 0
    buffer_store_dwordx4 v[96:99], v48, s[48:51], s3 offen sc1
    s_add_u32 s3, s52, 32768
    buffer_store_dwordx4 v[100:103], v48, s[48:51], s3 offen sc1
    s_waitcnt vmcnt(0)
    s_mov_b64 exec, 1
    buffer_store_dwordx2 v[8:9], v49, s[48:51], s53 offen offset:1024 sc1
    s_mov_b64 exec, -1
L_join_99:
    s_cmp_lg_u32 s54, 2
    s_cbranch_scc1 L_other_100
    v_lshlrev_b32 v50, 3, v66
    buffer_load_dwordx2 v[240:241], v50, s[48:51], s53 offen offset:1024 sc1
    s_waitcnt vmcnt(0)
L_chk_101:
    v_xor_b32 v4, s60, v240
    v_bitop3_b32 v4, v4, v241, s60 bitop3:0xf6
    v_cmp_ne_u32 vcc, 0, v4
    s_cbranch_vccz L_ok_102
    s_cmp_eq_u32 s64, 0
    s_cbranch_scc1 L_ok_102
    s_sub_u32 s64, s64, 1
    buffer_load_dwordx2 v[240:241], v50, s[48:51], s53 offen offset:1024 sc1
    s_waitcnt vmcnt(0)
    s_branch L_chk_101
L_ok_102:
    buffer_load_dwordx4 v[128:131], v22, s[48:51], s61 offen offset:0 sc1
    buffer_load_dwordx4 v[132:135], v22, s[48:51], s61 offen offset:1024 sc1
    buffer_load_dwordx4 v[136:139], v22, s[48:51], s61 offen offset:2048 sc1
    buffer_load_dwordx4 v[140:143], v22, s[48:51], s61 offen offset:3072 sc1
    buffer_load_dwordx4 v[144:147], v22, s[48:51], s68 offen offset:0 sc1
    buffer_load_dwordx4 v[148:151], v22, s[48:51], s68 offen offset:1024 sc1
    buffer_load_dwordx4 v[152:155], v22, s[48:51], s68 offen offset:2048 sc1
    buffer_load_dwordx4 v[156:159], v22, s[48:51], s68 offen offset:3072 sc1
L_other_100:
    s_waitcnt vmcnt(7)
    v_mfma_f32_16x16x32_bf16 v[112:115], v[24:27], v[128:131], 0
    s_waitcnt vmcnt(6)
    v_mfma_f32_16x16x32_bf16 v[112:115], v[28:31], v[132:135], v[112:115]
    s_waitcnt vmcnt(5)
    v_mfma_f32_16x16x32_bf16 v[116:119], v[24:27], v[136:139], 0
    s_waitcnt vmcnt(4)
    v_mfma_f32_16x16x32_bf16 v[116:119], v[28:31], v[140:143], v[116:119]
    s_waitcnt vmcnt(3)
    v_mfma_f32_16x16x32_bf16 v[120:123], v[24:27], v[144:147], 0
    s_waitcnt vmcnt(2)
    v_mfma_f32_16x16x32_bf16 v[120:123], v[28:31], v[148:151], v[120:123]
    s_waitcnt vmcnt(1)
    v_mfma_f32_16x16x32_bf16 v[124:127], v[24:27], v[152:155], 0
    s_waitcnt vmcnt(0)
    v_mfma_f32_16x16x32_bf16 v[124:127], v[28:31], v[156:159], v[124:127]
    s_mov_b64 exec, 1
    buffer_store_dwordx4 v[252:255], v6, s[48:51], 0 offen sc1
    s_mov_b64 exec, -1
    v_cmp_eq_u32 vcc, 1, v65
    s_nop 1
    v_cndmask_b32 v112, v112, v120, vcc
    v_cndmask_b32 v113, v113, v121, vcc
    v_cndmask_b32 v114, v114, v122, vcc
    v_cndmask_b32 v115, v115, v123, vcc
    v_cndmask_b32 v116, v116, v124, vcc
    v_cndmask_b32 v117, v117, v125, vcc
    v_cndmask_b32 v118, v118, v126, vcc
    v_cndmask_b32 v119, v119, v127, vcc
    v_cvt_pk_bf16_f32 v32, v112, v113
    v_cvt_pk_bf16_f32 v33, v114, v115
    v_cvt_pk_bf16_f32 v34, v116, v117
    v_cvt_pk_bf16_f32 v35, v118, v119
    s_nop 0
    v_permlane16_swap_b32 v32, v34
    v_permlane16_swap_b32 v33, v35
    v_lshrrev_b32 v4, 1, v32
    v_and_b32 v4, s1, v4
    v_add_u32 v32, v32, v4
    v_bfi_b32 v32, s1, v40, v32
    v_lshrrev_b32 v4, 1, v33
    v_and_b32 v4, s1, v4
    v_add_u32 v33, v33, v4
    v_bfi_b32 v33, s1, v41, v33
    v_lshrrev_b32 v4, 1, v34
    v_and_b32 v4, s1, v4
    v_add_u32 v34, v34, v4
    v_bfi_b32 v34, s1, v42, v34
    v_lshrrev_b32 v4, 1, v35
    v_and_b32 v4, s1, v4
    v_add_u32 v35, v35, v4
    v_bfi_b32 v35, s1, v43, v35
    buffer_store_dwordx4 v[32:35], v7, s[48:51], s59 offen sc1
    s_mov_b32 s36, s30
    s_and_b32 s37, s31, 0xffff
    s_mov_b32 s38, 4096
    s_mov_b32 s39, 0x20000
    v_cmp_gt_u32 vcc, 8, v2
    s_nop 1
    v_cndmask_b32 v152, v15, v14, vcc
    v_cndmask_b32 v153, v17, v16, vcc
    v_cndmask_b32 v154, v19, v18, vcc
    v_cndmask_b32 v155, v21, v20, vcc
    v_cmp_eq_u32 s[4:5], 15, v2
    v_and_b32 v4, 3, v2
    v_cmp_eq_u32 s[6:7], 0, v4
    v_mov_b32 v132, 0x7fff0000
    v_cndmask_b32 v131, 0, 1.0, s[4:5]
    v_lshlrev_b32 v130, 7, v3
    v_lshl_add_u32 v130, v2, 2, v130
    s_mul_i32 s3, s70, 2560
    v_add_u32 v130, s3, v130
    v_and_b32 v4, 1, v3
    v_lshlrev_b32 v4, 3, v4
    v_lshrrev_b32 v134, 1, v3
    v_lshl_add_u32 v4, v134, 11, v4
    s_lshl_b32 s3, s70, 8
    v_add_u32 v4, s3, v4
    v_lshl_add_u32 v134, v2, 4, v4
    v_cndmask_b32 v128, v134, v132, s[4:5]
    v_lshrrev_b32 v134, 1, v2
    v_add_u32 v134, v134, v4
    v_add_u32 v134, 240, v134
    v_cndmask_b32 v129, v132, v134, s[6:7]
    s_lshl_b32 s3, s71, 8
    v_lshlrev_b32 v46, 9, v3
    v_lshl_add_u32 v46, v2, 4, v46
    v_add_u32 v46, s3, v46
    s_lshr_b32 s62, s56, 1
    s_lshl_b32 s3, s57, 3
    s_add_u32 s3, s3, s62
    s_lshl_b32 s3, s3, 6
    s_add_u32 s68, s3, 327680
    v_mul_u32_u24 v44, 256, v3
    v_lshl_add_u32 v44, v2, 4, v44
    v_lshlrev_b32 v5, 4, v3
    s_mul_i32 s61, s57, 8192
    s_mul_i32 s3, s70, 2048
    s_add_u32 s61, s61, s3
    s_mul_i32 s3, s62, 1024
    s_add_u32 s61, s61, s3
    s_add_u32 s61, s61, 1048576
    s_lshl_b32 s3, s56, 8
    s_add_u32 s3, s3, 149504
    v_and_b32 v6, 1, v3
    v_lshlrev_b32 v6, 3, v6
    v_lshl_add_u32 v6, v2, 4, v6
    v_add_u32 v7, s3, v6
    s_lshl_b32 s3, s56, 7
    s_add_u32 s3, s3, 149504
    v_lshrrev_b32 v4, 3, v2
    v_lshlrev_b32 v4, 9, v4
    v_lshl_add_u32 v4, v3, 5, v4
    v_add_u32 v8, s3, v4
    buffer_load_dwordx4 v[248:251], v5, s[48:51], s68 offen sc1
    s_waitcnt vmcnt(0)
L_chk_103:
    v_xor_b32 v4, s60, v250
    v_bitop3_b32 v4, v4, v251, s60 bitop3:0xf6
    v_cmp_ne_u32 vcc, 0, v4
    s_cbranch_vccz L_ok_104
    s_cmp_eq_u32 s64, 0
    s_cbranch_scc1 L_ok_104
    s_sub_u32 s64, s64, 1
    buffer_load_dwordx4 v[248:251], v5, s[48:51], s68 offen sc1
    s_waitcnt vmcnt(0)
    s_branch L_chk_103
L_ok_104:
    buffer_load_dwordx4 v[72:75], v44, s[48:51], s61 offen sc1
    v_mov_b32 v4, v248
    v_mov_b32 v252, v4
    s_nop 1
    v_permlane16_swap_b32 v252, v4
    v_max_f32 v4, v4, v252
    v_mov_b32 v252, v4
    s_nop 1
    v_permlane32_swap_b32 v252, v4
    v_max_f32 v4, v4, v252
    v_sub_f32 v4, v248, v4
    v_exp_f32 v4, v4
    s_nop 0
    v_mul_f32 v5, v4, v249
    v_mov_b32 v252, v5
    s_nop 1
    v_permlane16_swap_b32 v252, v5
    v_add_f32 v5, v5, v252
    v_mov_b32 v252, v5
    s_nop 1
    v_permlane32_swap_b32 v252, v5
    v_add_f32 v5, v5, v252
    v_rcp_f32 v5, v5
    s_nop 0
    v_mul_f32 v4, v4, v5
    v_cvt_pk_bf16_f32 v248, v4, v4
    v_and_b32 v24, v248, v10
    v_and_b32 v25, v248, v11
    v_and_b32 v26, v248, v12
    v_and_b32 v27, v248, v13
    s_waitcnt vmcnt(0)
L_chk_105:
    v_xor_b32 v72, v40, v72
    v_xor_b32 v73, v41, v73
    v_xor_b32 v74, v42, v74
    v_xor_b32 v75, v43, v75
    v_or_b32 v4, v72, v73
    v_or3_b32 v4, v4, v74, v75
    v_and_b32 v4, s1, v4
    v_cmp_ne_u32 vcc, 0, v4
    s_cbranch_vccz L_ok_106
    s_cmp_eq_u32 s64, 0
    s_cbranch_scc1 L_ok_106
    s_sub_u32 s64, s64, 1
    buffer_load_dwordx4 v[72:75], v44, s[48:51], s61 offen sc1
    s_waitcnt vmcnt(0)
    s_branch L_chk_105
L_ok_106:
    v_mfma_f32_16x16x32_bf16 v[32:35], v[24:27], v[72:75], 0
    s_nop 7
    v_cvt_pk_bf16_f32 v32, v32, v33
    v_cvt_pk_bf16_f32 v33, v34, v35
    ds_write_b64 v7, v[32:33]
    s_waitcnt lgkmcnt(0)
    s_barrier
    ds_read_b128 v[72:75], v8
    ds_read_b128 v[76:79], v8 offset:16
    s_or_b32 s3, s69, s56
    s_cmp_lg_u32 s3, 0
    s_cbranch_scc1 L_noepoch_107
    v_mov_b32 v4, 0
    s_mov_b64 exec, 1
    buffer_store_dword v9, v4, s[48:51], 0 offen sc1
    s_mov_b64 exec, -1
L_noepoch_107:
    s_lshl_b32 s3, s56, 10
    s_add_u32 s3, s3, 151552
    v_add_u32 v7, s3, v22
    v_add_u32 v8, 151552, v22
    v_lshrrev_b32 v4, 1, v3
    v_lshlrev_b32 v6, 1, v6
    v_lshl_add_u32 v6, v4, 9, v6
    s_lshl_b32 s61, s69, 10
    s_add_u32 s61, s61, 458752
    s_waitcnt lgkmcnt(0)
    v_perm_b32 v24, v72, v72, v14
    v_perm_b32 v25, v72, v72, v16
    v_perm_b32 v26, v72, v72, v18
    v_perm_b32 v27, v72, v72, v20
    v_perm_b32 v28, v72, v72, v15
    v_perm_b32 v29, v72, v72, v17
    v_perm_b32 v30, v72, v72, v19
    v_perm_b32 v31, v72, v72, v21
    v_mfma_f32_16x16x32_bf16 v[32:35], v[24:27], v[176:179], 0
    v_perm_b32 v24, v73, v73, v14
    v_perm_b32 v25, v73, v73, v16
    v_perm_b32 v26, v73, v73, v18
    v_perm_b32 v27, v73, v73, v20
    v_mfma_f32_16x16x32_bf16 v[32:35], v[28:31], v[180:183], v[32:35]
    v_perm_b32 v28, v73, v73, v15
    v_perm_b32 v29, v73, v73, v17
    v_perm_b32 v30, v73, v73, v19
    v_perm_b32 v31, v73, v73, v21
    v_mfma_f32_16x16x32_bf16 v[32:35], v[24:27], v[184:187], v[32:35]
    v_perm_b32 v24, v74, v74, v14
    v_perm_b32 v25, v74, v74, v16
    v_perm_b32 v26, v74, v74, v18
    v_perm_b32 v27, v74, v74, v20
    v_mfma_f32_16x16x32_bf16 v[32:35], v[28:31], v[188:191], v[32:35]
    v_perm_b32 v28, v74, v74, v15
    v_perm_b32 v29, v74, v74, v17
    v_perm_b32 v30, v74, v74, v19
    v_perm_b32 v31, v74, v74, v21
    v_mfma_f32_16x16x32_bf16 v[32:35], v[24:27], v[192:195], v[32:35]
    v_perm_b32 v24, v75, v75, v14
    v_perm_b32 v25, v75, v75, v16
    v_perm_b32 v26, v75, v75, v18
    v_perm_b32 v27, v75, v75, v20
    v_mfma_f32_16x16x32_bf16 v[32:35], v[28:31], v[196:199], v[32:35]
    v_perm_b32 v28, v75, v75, v15
    v_perm_b32 v29, v75, v75, v17
    v_perm_b32 v30, v75, v75, v19
    v_perm_b32 v31, v75, v75, v21
    v_mfma_f32_16x16x32_bf16 v[32:35], v[24:27], v[200:203], v[32:35]
    v_perm_b32 v24, v76, v76, v14
    v_perm_b32 v25, v76, v76, v16
    v_perm_b32 v26, v76, v76, v18
    v_perm_b32 v27, v76, v76, v20
    v_mfma_f32_16x16x32_bf16 v[32:35], v[28:31], v[204:207], v[32:35]
    v_perm_b32 v28, v76, v76, v15
    v_perm_b32 v29, v76, v76, v17
    v_perm_b32 v30, v76, v76, v19
    v_perm_b32 v31, v76, v76, v21
    v_mfma_f32_16x16x32_bf16 v[32:35], v[24:27], v[208:211], v[32:35]
    v_perm_b32 v24, v77, v77, v14
    v_perm_b32 v25, v77, v77, v16
    v_perm_b32 v26, v77, v77, v18
    v_perm_b32 v27, v77, v77, v20
    v_mfma_f32_16x16x32_bf16 v[32:35], v[28:31], v[212:215], v[32:35]
    v_perm_b32 v28, v77, v77, v15
    v_perm_b32 v29, v77, v77, v17
    v_perm_b32 v30, v77, v77, v19
    v_perm_b32 v31, v77, v77, v21
    v_mfma_f32_16x16x32_bf16 v[32:35], v[24:27], v[216:219], v[32:35]
    v_perm_b32 v24, v78, v78, v14
    v_perm_b32 v25, v78, v78, v16
    v_perm_b32 v26, v78, v78, v18
    v_perm_b32 v27, v78, v78, v20
    v_mfma_f32_16x16x32_bf16 v[32:35], v[28:31], v[220:223], v[32:35]
    v_perm_b32 v28, v78, v78, v15
    v_perm_b32 v29, v78, v78, v17
    v_perm_b32 v30, v78, v78, v19
    v_perm_b32 v31, v78, v78, v21
    v_mfma_f32_16x16x32_bf16 v[32:35], v[24:27], v[224:227], v[32:35]
    v_perm_b32 v24, v79, v79, v14
    v_perm_b32 v25, v79, v79, v16
    v_perm_b32 v26, v79, v79, v18
    v_perm_b32 v27, v79, v79, v20
    v_mfma_f32_16x16x32_bf16 v[32:35], v[28:31], v[228:231], v[32:35]
    v_perm_b32 v28, v79, v79, v15
    v_perm_b32 v29, v79, v79, v17
    v_perm_b32 v30, v79, v79, v19
    v_perm_b32 v31, v79, v79, v21
    v_mfma_f32_16x16x32_bf16 v[32:35], v[24:27], v[232:235], v[32:35]
    s_nop 0
    v_mfma_f32_16x16x32_bf16 v[32:35], v[28:31], v[236:239], v[32:35]
    s_nop 7
    ds_write_b128 v7, v[32:35]
    s_waitcnt lgkmcnt(0)
    s_barrier
    s_cmp_lg_u32 s56, 0
    s_cbranch_scc1 L_nopub_108
    ds_read_b128 v[72:75], v8 offset:0
    ds_read_b128 v[76:79], v8 offset:1024
    ds_read_b128 v[80:83], v8 offset:2048
    ds_read_b128 v[84:87], v8 offset:3072
    s_waitcnt lgkmcnt(0)
    v_add_f32 v72, v72, v76
    v_add_f32 v80, v80, v84
    v_add_f32 v73, v73, v77
    v_add_f32 v81, v81, v85
    v_add_f32 v74, v74, v78
    v_add_f32 v82, v82, v86
    v_add_f32 v75, v75, v79
    v_add_f32 v83, v83, v87
    v_add_f32 v72, v72, v80
    v_add_f32 v73, v73, v81
    v_add_f32 v74, v74, v82
    v_add_f32 v75, v75, v83
    v_add_u32 v72, 0x800, v72
    v_add_u32 v73, 0x800, v73
    v_add_u32 v74, 0x800, v74
    v_add_u32 v75, 0x800, v75
    v_bfi_b32 v72, s65, v9, v72
    v_bfi_b32 v73, s65, v9, v73
    v_bfi_b32 v74, s65, v9, v74
    v_bfi_b32 v75, s65, v9, v75
    s_cmp_eq_u32 s0, 0
    s_cbranch_scc1 L_far_109
    buffer_store_dwordx4 v[72:75], v6, s[48:51], s61 offen
    s_branch L_join_110
L_far_109:
    buffer_store_dwordx4 v[72:75], v6, s[48:51], s61 offen sc1
L_join_110:
    s_nop 1
L_nopub_108:
    s_lshl_b32 s68, s57, 11
    s_add_u32 s68, s68, 458752
    buffer_load_dwordx4 v[88:91], v46, s[48:51], s68 offen sc1
    s_waitcnt vmcnt(0)
L_chk_111:
    v_xor_b32 v4, s60, v88
    v_bitop3_b32 v4, v4, v89, s60 bitop3:0xf6
    v_bitop3_b32 v4, v4, v90, s60 bitop3:0xf6
    v_bitop3_b32 v4, v4, v91, s60 bitop3:0xf6
    v_and_b32 v4, s65, v4
    v_cmp_ne_u32 vcc, 0, v4
    s_cbranch_vccz L_ok_112
    s_cmp_eq_u32 s64, 0
    s_cbranch_scc1 L_ok_112
    s_sub_u32 s64, s64, 1
    buffer_load_dwordx4 v[88:91], v46, s[48:51], s68 offen sc1
    s_waitcnt vmcnt(0)
    s_branch L_chk_111
L_ok_112:
    s_mov_b32 s3, 0
    buffer_load_dwordx4 a[192:195], v68, s[44:47], s3 offen
    s_mov_b32 s3, 4096
    buffer_load_dwordx4 a[196:199], v68, s[44:47], s3 offen
    s_mov_b32 s3, 8192
    buffer_load_dwordx4 a[200:203], v68, s[44:47], s3 offen
    s_mov_b32 s3, 12288
    buffer_load_dwordx4 a[204:207], v68, s[44:47], s3 offen
    s_mov_b32 s3, 16384
    buffer_load_dwordx4 a[208:211], v68, s[44:47], s3 offen
    s_mov_b32 s3, 20480
    buffer_load_dwordx4 a[212:215], v68, s[44:47], s3 offen
    s_mov_b32 s3, 24576
    buffer_load_dwordx4 a[216:219], v68, s[44:47], s3 offen
    s_mov_b32 s3, 28672
    buffer_load_dwordx4 a[220:223], v68, s[44:47], s3 offen
    v_and_b32 v88, s66, v88
    v_and_b32 v89, s66, v89
    v_and_b32 v90, s66, v90
    v_and_b32 v91, s66, v91
    s_nop 0
    v_permlane32_swap_b32 v88, v90
    v_permlane32_swap_b32 v89, v91
    v_add_f32 v88, v88, v90
    v_add_f32 v89, v89, v91
    s_nop 1
    v_permlane16_swap_b32 v88, v89
    v_cvt_pk_bf16_f32 v88, v88, v89
    s_nop 1
    v_mov_b32_dpp v134, v88 row_newbcast:0 row_mask:0xf bank_mask:0xf
    v_perm_b32 v176, v134, v134, v152
    v_perm_b32 v177, v134, v134, v153
    v_perm_b32 v178, v134, v134, v154
    v_perm_b32 v179, v134, v134, v155
    v_mov_b32_dpp v135, v88 row_newbcast:1 row_mask:0xf bank_mask:0xf
    v_perm_b32 v180, v135, v135, v152
    v_perm_b32 v181, v135, v135, v153
    v_perm_b32 v182, v135, v135, v154
    v_perm_b32 v183, v135, v135, v155
    v_mov_b32_dpp v134, v88 row_newbcast:2 row_mask:0xf bank_mask:0xf
    v_perm_b32 v184, v134, v134, v152
    v_perm_b32 v185, v134, v134, v153
    v_perm_b32 v186, v134, v134, v154
    v_perm_b32 v187, v134, v134, v155
    v_mov_b32_dpp v135, v88 row_newbcast:3 row_mask:0xf bank_mask:0xf
    v_perm_b32 v188, v135, v135, v152
    v_perm_b32 v189, v135, v135, v153
    v_perm_b32 v190, v135, v135, v154
    v_perm_b32 v191, v135, v135, v155
    v_mov_b32_dpp v134, v88 row_newbcast:4 row_mask:0xf bank_mask:0xf
    v_perm_b32 v192, v134, v134, v152
    v_perm_b32 v193, v134, v134, v153
    v_perm_b32 v194, v134, v134, v154
    v_perm_b32 v195, v134, v134, v155
    v_mov_b32_dpp v135, v88 row_newbcast:5 row_mask:0xf bank_mask:0xf
    v_perm_b32 v196, v135, v135, v152
    v_perm_b32 v197, v135, v135, v153
    v_perm_b32 v198, v135, v135, v154
    v_perm_b32 v199, v135, v135, v155
    v_mov_b32_dpp v134, v88 row_newbcast:6 row_mask:0xf bank_mask:0xf
    v_perm_b32 v200, v134, v134, v152
    v_perm_b32 v201, v134, v134, v153
    v_perm_b32 v202, v134, v134, v154
    v_perm_b32 v203, v134, v134, v155
    v_mov_b32_dpp v135, v88 row_newbcast:7 row_mask:0xf bank_mask:0xf
    v_perm_b32 v204, v135, v135, v152
    v_perm_b32 v205, v135, v135, v153
    v_perm_b32 v206, v135, v135, v154
    v_perm_b32 v207, v135, v135, v155
    v_mov_b32_dpp v134, v88 row_newbcast:8 row_mask:0xf bank_mask:0xf
    v_perm_b32 v208, v134, v134, v152
    v_perm_b32 v209, v134, v134, v153
    v_perm_b32 v210, v134, v134, v154
    v_perm_b32 v211, v134, v134, v155
    v_mov_b32_dpp v135, v88 row_newbcast:9 row_mask:0xf bank_mask:0xf
    v_perm_b32 v212, v135, v135, v152
    v_perm_b32 v213, v135, v135, v153
    v_perm_b32 v214, v135, v135, v154
    v_perm_b32 v215, v135, v135, v155
    v_mov_b32_dpp v134, v88 row_newbcast:10 row_mask:0xf bank_mask:0xf
    v_perm_b32 v216, v134, v134, v152
    v_perm_b32 v217, v134, v134, v153
    v_perm_b32 v218, v134, v134, v154
    v_perm_b32 v219, v134, v134, v155
    v_mov_b32_dpp v135, v88 row_newbcast:11 row_mask:0xf bank_mask:0xf
    v_perm_b32 v220, v135, v135, v152
    v_perm_b32 v221, v135, v135, v153
    v_perm_b32 v222, v135, v135, v154
    v_perm_b32 v223, v135, v135, v155
    v_mov_b32_dpp v134, v88 row_newbcast:12 row_mask:0xf bank_mask:0xf
    v_perm_b32 v224, v134, v134, v152
    v_perm_b32 v225, v134, v134, v153
    v_perm_b32 v226, v134, v134, v154
    v_perm_b32 v227, v134, v134, v155
    v_mov_b32_dpp v135, v88 row_newbcast:13 row_mask:0xf bank_mask:0xf
    v_perm_b32 v228, v135, v135, v152
    v_perm_b32 v229, v135, v135, v153
    v_perm_b32 v230, v135, v135, v154
    v_perm_b32 v231, v135, v135, v155
    v_mov_b32_dpp v134, v88 row_newbcast:14 row_mask:0xf bank_mask:0xf
    v_perm_b32 v232, v134, v134, v152
    v_perm_b32 v233, v134, v134, v153
    v_perm_b32 v234, v134, v134, v154
    v_perm_b32 v235, v134, v134, v155
    v_mov_b32_dpp v135, v88 row_newbcast:15 row_mask:0xf bank_mask:0xf
    v_perm_b32 v236, v135, v135, v152
    v_perm_b32 v237, v135, v135, v153
    v_perm_b32 v238, v135, v135, v154
    v_perm_b32 v239, v135, v135, v155
    s_mov_b32 s3, 32768
    buffer_load_dwordx4 a[224:227], v68, s[44:47], s3 offen
    s_mov_b32 s3, 36864
    buffer_load_dwordx4 a[228:231], v68, s[44:47], s3 offen
    s_mov_b32 s3, 40960
    buffer_load_dwordx4 a[232:235], v68, s[44:47], s3 offen
    s_mov_b32 s3, 45056
    buffer_load_dwordx4 a[236:239], v68, s[44:47], s3 offen
    s_mov_b32 s3, 49152
    buffer_load_dwordx4 a[240:243], v68, s[44:47], s3 offen
    s_mov_b32 s3, 53248
    buffer_load_dwordx4 a[244:247], v68, s[44:47], s3 offen
    s_mov_b32 s3, 57344
    buffer_load_dwordx4 a[248:251], v68, s[44:47], s3 offen
    s_mov_b32 s3, 61440
    buffer_load_dwordx4 a[252:255], v68, s[44:47], s3 offen
    s_waitcnt vmcnt(15)
    v_mfma_f32_16x16x32_bf16 v[32:35], v[176:179], a[192:195], 0
    s_waitcnt vmcnt(14)
    v_mfma_f32_16x16x32_bf16 v[32:35], v[180:183], a[196:199], v[32:35]
    s_waitcnt vmcnt(13)
    v_mfma_f32_16x16x32_bf16 v[32:35], v[184:187], a[200:203], v[32:35]
    s_waitcnt vmcnt(12)
    v_mfma_f32_16x16x32_bf16 v[32:35], v[188:191], a[204:207], v[32:35]
    s_waitcnt vmcnt(11)
    v_mfma_f32_16x16x32_bf16 v[32:35], v[192:195], a[208:211], v[32:35]
    s_waitcnt vmcnt(10)
    v_mfma_f32_16x16x32_bf16 v[32:35], v[196:199], a[212:215], v[32:35]
    s_waitcnt vmcnt(9)
    v_mfma_f32_16x16x32_bf16 v[32:35], v[200:203], a[216:219], v[32:35]
    s_waitcnt vmcnt(8)
    v_mfma_f32_16x16x32_bf16 v[32:35], v[204:207], a[220:223], v[32:35]
    s_waitcnt vmcnt(7)
    v_mfma_f32_16x16x32_bf16 v[32:35], v[208:211], a[224:227], v[32:35]
    s_waitcnt vmcnt(6)
    v_mfma_f32_16x16x32_bf16 v[32:35], v[212:215], a[228:231], v[32:35]
    s_waitcnt vmcnt(5)
    v_mfma_f32_16x16x32_bf16 v[32:35], v[216:219], a[232:235], v[32:35]
    s_waitcnt vmcnt(4)
    v_mfma_f32_16x16x32_bf16 v[32:35], v[220:223], a[236:239], v[32:35]
    s_waitcnt vmcnt(3)
    v_mfma_f32_16x16x32_bf16 v[32:35], v[224:227], a[240:243], v[32:35]
    s_waitcnt vmcnt(2)
    v_mfma_f32_16x16x32_bf16 v[32:35], v[228:231], a[244:247], v[32:35]
    s_waitcnt vmcnt(1)
    v_mfma_f32_16x16x32_bf16 v[32:35], v[232:235], a[248:251], v[32:35]
    s_waitcnt vmcnt(0)
    v_mfma_f32_16x16x32_bf16 v[32:35], v[236:239], a[252:255], v[32:35]
    s_mov_b32 s3, 26624
    s_mov_b32 s61, 28672
    s_nop 5
    v_cndmask_b32 v136, v32, 1.0, s[4:5]
    buffer_atomic_add_f32 v136, v130, s[48:51], s3 offen offset:0 sc0 sc1
    v_cndmask_b32 v137, v33, 1.0, s[4:5]
    buffer_atomic_add_f32 v137, v130, s[48:51], s3 offen offset:512 sc0 sc1
    v_cndmask_b32 v138, v34, 1.0, s[4:5]
    buffer_atomic_add_f32 v138, v130, s[48:51], s3 offen offset:1024 sc0 sc1
    v_cndmask_b32 v139, v35, 1.0, s[4:5]
    buffer_atomic_add_f32 v139, v130, s[48:51], s3 offen offset:1536 sc0 sc1
    v_mov_b32_dpp v141, v32 row_newbcast:15 row_mask:0xf bank_mask:1
    s_nop 1
    v_mov_b32_dpp v141, v33 row_newbcast:15 row_mask:0xf bank_mask:2
    s_nop 1
    v_mov_b32_dpp v141, v34 row_newbcast:15 row_mask:0xf bank_mask:4
    s_nop 1
    v_mov_b32_dpp v141, v35 row_newbcast:15 row_mask:0xf bank_mask:8
    v_cndmask_b32 v140, v131, v141, s[6:7]
    buffer_atomic_add_f32 v140, v130, s[48:51], s61 offen sc0 sc1
    s_waitcnt vmcnt(0)
    v_mov_b32_dpp v144, v136 row_newbcast:15 row_mask:0xf bank_mask:0xf
    v_mov_b32_dpp v145, v137 row_newbcast:15 row_mask:0xf bank_mask:0xf
    v_mov_b32_dpp v146, v138 row_newbcast:15 row_mask:0xf bank_mask:0xf
    v_mov_b32_dpp v147, v139 row_newbcast:15 row_mask:0xf bank_mask:0xf
    v_mov_b32_dpp v148, v140 row_newbcast:15 row_mask:0xf bank_mask:0xf
    v_cmp_eq_f32 vcc, 0x427c0000, v144
    v_add_f32 v136, v136, v32
    v_cvt_pk_bf16_f32 v136, v136, v136
    v_cndmask_b32 v144, v132, v128, vcc
    buffer_store_short v136, v144, s[36:39], 0 offen offset:1024
    v_cmp_eq_f32 vcc, 0x427c0000, v145
    v_add_f32 v137, v137, v33
    v_cvt_pk_bf16_f32 v137, v137, v137
    v_cndmask_b32 v145, v132, v128, vcc
    buffer_store_short v137, v145, s[36:39], 0 offen offset:1026
    v_cmp_eq_f32 vcc, 0x427c0000, v146
    v_add_f32 v138, v138, v34
    v_cvt_pk_bf16_f32 v138, v138, v138
    v_cndmask_b32 v146, v132, v128, vcc
    buffer_store_short v138, v146, s[36:39], 0 offen offset:1028
    v_cmp_eq_f32 vcc, 0x427c0000, v147
    v_add_f32 v139, v139, v35
    v_cvt_pk_bf16_f32 v139, v139, v139
    v_cndmask_b32 v147, v132, v128, vcc
    buffer_store_short v139, v147, s[36:39], 0 offen offset:1030
    v_cmp_eq_f32 vcc, 0x427c0000, v148
    v_add_f32 v140, v140, v141
    v_cvt_pk_bf16_f32 v140, v140, v140
    v_cndmask_b32 v148, v132, v129, vcc
    buffer_store_short v140, v148, s[36:39], 0 offen offset:1024
    s_endpgm
L_code_end:
.section .rodata,"a"
.p2align 6
.amdhsa_kernel concat_heads__sliding_block_cached__compressed_kv_cla__decode_kernel
  .amdhsa_next_free_vgpr 512
  .amdhsa_next_free_sgpr 102
  .amdhsa_accum_offset 256
  .amdhsa_group_segment_fixed_size 0
  .amdhsa_kernarg_size 112
  .amdhsa_user_sgpr_count 2
  .amdhsa_user_sgpr_kernarg_segment_ptr 1
  .amdhsa_system_sgpr_workgroup_id_x 1
.end_amdhsa_kernel
```
